```python
import torch

def _softmax(x, axis=-1):
    return torch.softmax(x, dim=axis)
def _gelu(x):
    return torch.nn.functional.gelu(x, approximate="tanh")
def _silu(x):
    return torch.nn.functional.silu(x)
def _sigmoid(x):
    return torch.sigmoid(x)
def _layernorm(x, axis=-1, eps=1e-5):
    m = x.mean(dim=axis, keepdim=True)
    v = x.var(dim=axis, keepdim=True, unbiased=False)
    return (x - m) / torch.sqrt(v + eps)
def _scatter_add(tgt, idx, src, axis=0):
    return tgt.clone().index_add_(axis, idx, src)
def _segment_sum(src, seg, n):
    out = torch.zeros((n,) + src.shape[1:], dtype=src.dtype)
    return out.index_add_(0, seg, src)
def _pad(x, pw):
    flat = tuple(v for pair in reversed(pw) for v in pair)
    return torch.nn.functional.pad(x, flat)

kernel_name = 'concat_heads__gqa_block_cached__sliding_block_cached__decode'

def setup_inputs():

    _w = (lambda a: (lambda t: t.to(torch.bfloat16) if t.is_floating_point() else t)(torch.as_tensor(a)))
    def _A_setup():
        B, Sq, D = 2, 1, 448
        Hq, Hkv, Sk, Dh = 16, 8, 8192, 256
        assert Hq % Hkv == 0, (Hq, Hkv)
        return {
            "x": _w((lambda *s: torch.randn(*s, dtype=torch.bfloat16) * 0.8)(B, Sq, D)),
            "k_cache": _w((lambda *s: torch.randn(*s, dtype=torch.bfloat16) * 1.6)(B, Hkv, Sk, Dh)),
            "v_cache": _w((lambda *s: torch.randn(*s, dtype=torch.bfloat16) * 0.2)(B, Hkv, Sk, Dh)),
            "wq": _w((lambda *s: torch.randn(*s, dtype=torch.bfloat16) * 1.6)(D, Hq * Dh) * (D ** -0.5)),
            "wo": _w((lambda *s: torch.randn(*s, dtype=torch.bfloat16) * 0.2)(Hq * Dh, D) * ((Hq * Dh) ** -0.5)),
        }
    _A_in = _A_setup()

    def _B_setup():
        B, Sq, D = 2, 1, 448
        Hq, Hkv, Sk, Dh = 16, 8, 8192, 256
        assert Hq % Hkv == 0, (Hq, Hkv)
        return {
            "x": _w((lambda *s: torch.randn(*s, dtype=torch.bfloat16) * 0.8)(B, Sq, D)),
            "k_cache": _w((lambda *s: torch.randn(*s, dtype=torch.bfloat16) * 1.6)(B, Hkv, Sk, Dh)),
            "v_cache": _w((lambda *s: torch.randn(*s, dtype=torch.bfloat16) * 0.2)(B, Hkv, Sk, Dh)),
            "wq": _w((lambda *s: torch.randn(*s, dtype=torch.bfloat16) * 1.6)(D, Hq * Dh) * (D ** -0.5)),
            "wo": _w((lambda *s: torch.randn(*s, dtype=torch.bfloat16) * 0.2)(Hq * Dh, D) * ((Hq * Dh) ** -0.5)),
        }
    _B_in = _B_setup()

    return {
        "A_x": _A_in["x"],
        "A_k_cache": _A_in["k_cache"],
        "A_v_cache": _A_in["v_cache"],
        "A_wq": _A_in["wq"],
        "A_wo": _A_in["wo"],
        "B_x": _B_in["x"],
        "B_k_cache": _B_in["k_cache"],
        "B_v_cache": _B_in["v_cache"],
        "B_wq": _B_in["wq"],
        "B_wo": _B_in["wo"],
    }

def reference(A_x, A_k_cache, A_v_cache, A_wq, A_wo, B_x, B_k_cache, B_v_cache, B_wq, B_wo):
    def _A_ref(x, k_cache, v_cache, wq, wo):
        B, Sq, D = x.shape
        Hq, Dh = 16, 256
        Hkv = k_cache.shape[1]
        rep = Hq // Hkv
        q = (lambda x, *d: x.permute(*d))((x @ wq).reshape(B, Sq, Hq, Dh), 0, 2, 1, 3)
        k = (lambda x, n, axis: torch.repeat_interleave(x, n, dim=axis))(k_cache, rep, axis=1)
        v = (lambda x, n, axis: torch.repeat_interleave(x, n, dim=axis))(v_cache, rep, axis=1)
        scores = torch.einsum("bhqd,bhkd->bhqk", q, k) * (Dh ** -0.5)
        p = _softmax(scores, axis=-1)
        o = torch.einsum("bhqk,bhkd->bhqd", p, v)
        return (lambda x, *d: x.permute(*d))(o, 0, 2, 1, 3).reshape(B, Sq, Hq * Dh) @ wo

    def _B_ref(x, k_cache, v_cache, wq, wo):
        B, Sq, D = x.shape
        Hq, Dh = 16, 256
        Hkv, Sk = k_cache.shape[1], k_cache.shape[2]
        W = min(4096, max(256, Sk // 4))
        rep = Hq // Hkv
        q = (lambda x, *d: x.permute(*d))((x @ wq).reshape(B, Sq, Hq, Dh), 0, 2, 1, 3)
        k = (lambda x, n, axis: torch.repeat_interleave(x, n, dim=axis))(k_cache[:, :, Sk - W:, :], rep, axis=1)
        v = (lambda x, n, axis: torch.repeat_interleave(x, n, dim=axis))(v_cache[:, :, Sk - W:, :], rep, axis=1)
        scores = torch.einsum("bhqd,bhkd->bhqk", q, k) * (Dh ** -0.5)
        p = _softmax(scores, axis=-1)
        o = torch.einsum("bhqk,bhkd->bhqd", p, v)
        return (lambda x, *d: x.permute(*d))(o, 0, 2, 1, 3).reshape(B, Sq, Hq * Dh) @ wo

    a = _A_ref(A_x, A_k_cache, A_v_cache, A_wq, A_wo)
    b = _B_ref(B_x, B_k_cache, B_v_cache, B_wq, B_wo)
    return torch.concatenate([a, b], axis=-1)
```

```asm
; @launch grid=(256,1,1) block=(320,1,1) lds=18832
.amdgcn_target "amdgcn-amd-amdhsa--gfx950"
.text
.globl concat_heads__gqa_block_cached__sliding_block_cached__decode_kernel
.p2align 8
.type concat_heads__gqa_block_cached__sliding_block_cached__decode_kernel,@function
concat_heads__gqa_block_cached__sliding_block_cached__decode_kernel:
    s_cmp_ge_u32 s2, 256
    s_cbranch_scc1 L_end
    s_load_dwordx16 s[4:19], s[0:1], 0
    s_load_dwordx8 s[20:27], s[0:1], 64
    s_load_dwordx2 s[28:29], s[0:1], 96
    v_lshrrev_b32 v1, 6, v0
    v_and_b32 v0, 63, v0
    v_readfirstlane_b32 s3, v1
    s_and_b32 s31, s2, 7
    s_bfe_u32 s32, s2, 0x10003
    s_lshr_b32 s33, s2, 4
    s_lshl_b32 s34, s32, 4
    s_add_u32 s34, s34, s33
    v_and_b32 v2, 15, v0
    v_lshrrev_b32 v3, 4, v0
    s_cmp_eq_u32 s3, 0
    s_cbranch_scc1 L_helper
    s_sub_u32 s3, s3, 1
    v_lshrrev_b32 v8, 2, v2
    v_lshlrev_b32 v4, 11, v8
    v_lshl_add_u32 v4, v3, 6, v4
    v_and_b32 v8, 3, v0
    v_lshl_add_u32 v4, v8, 4, v4
    v_lshlrev_b32 v5, 11, v3
    v_lshl_add_u32 v5, v2, 4, v5
    s_lshl_b32 s35, s32, 3
    s_add_u32 s35, s35, s31
    s_lshl_b32 s35, s35, 22
    s_lshl_b32 s54, s3, 13
    s_add_u32 s35, s35, s54
    s_lshl_b32 s52, s33, 18
    s_add_u32 s52, s52, s35
    s_lshl_b32 s53, s33, 16
    s_add_u32 s53, s53, s35
    s_add_u32 s53, s53, 0x300000
    s_waitcnt lgkmcnt(0)
    s_mov_b32 s40, s6
    s_mov_b32 s41, s7
    s_mov_b32 s42, 0x4000000
    s_mov_b32 s43, 0x20000
    s_barrier
    s_add_u32 s55, s52, 0
    buffer_load_dwordx4 v[100:103], v4, s[40:43], s55 offen offset:0 nt
    buffer_load_dwordx4 v[104:107], v4, s[40:43], s55 offen offset:256 nt
    buffer_load_dwordx4 v[108:111], v4, s[40:43], s55 offen offset:512 nt
    buffer_load_dwordx4 v[112:115], v4, s[40:43], s55 offen offset:768 nt
    buffer_load_dwordx4 v[116:119], v4, s[40:43], s55 offen offset:1024 nt
    buffer_load_dwordx4 v[120:123], v4, s[40:43], s55 offen offset:1280 nt
    buffer_load_dwordx4 v[124:127], v4, s[40:43], s55 offen offset:1536 nt
    buffer_load_dwordx4 v[128:131], v4, s[40:43], s55 offen offset:1792 nt
    s_load_dword s30, s[28:29], 0
    s_mov_b32 s44, s8
    s_mov_b32 s45, s9
    s_mov_b32 s46, 0x4000000
    s_mov_b32 s47, 0x20000
    s_mov_b32 s48, s16
    s_mov_b32 s49, s17
    s_mov_b32 s50, 0x4000000
    s_mov_b32 s51, 0x20000
    s_mov_b32 s88, s18
    s_mov_b32 s89, s19
    s_mov_b32 s90, 0x4000000
    s_mov_b32 s91, 0x20000
    s_mov_b32 s36, s28
    s_mov_b32 s37, s29
    s_mov_b32 s38, 0x400000
    s_mov_b32 s39, 0x20000
    s_cmp_ge_u32 s34, 16
    s_cselect_b32 s92, s22, s12
    s_cselect_b32 s93, s23, s13
    s_mov_b32 s94, 0x380000
    s_mov_b32 s95, 0x20000
    s_and_b32 s54, s34, 15
    s_lshl_b32 s54, s54, 5
    s_lshl_b32 s63, s31, 9
    s_add_u32 s63, s63, s54
    s_mul_i32 s63, s63, 896
    v_mul_u32_u24 v6, 7168, v3
    v_lshl_add_u32 v6, v2, 4, v6
    s_lshl_b32 s54, s3, 8
    v_add_u32 v6, s54, v6
    s_lshl_b32 s54, s3, 4
    v_add_u32 v8, s54, v2
    v_mov_b32 v14, v8
    v_cmp_gt_u32 vcc, 56, v8
    v_mov_b32 v9, 0x40000000
    s_nop 0
    v_cndmask_b32 v6, v9, v6, vcc
    v_and_b32 v8, 1, v0
    v_lshlrev_b32 v8, 4, v8
    v_mov_b32 v9, 0xffff
    v_lshlrev_b32 v9, v8, v9
    v_bfe_u32 v8, v0, 1, 2
    v_cmp_eq_u32 vcc, 0, v8
    s_nop 1
    v_cndmask_b32 v10, 0, v9, vcc
    v_cmp_eq_u32 vcc, 1, v8
    s_nop 1
    v_cndmask_b32 v11, 0, v9, vcc
    v_cmp_eq_u32 vcc, 2, v8
    s_nop 1
    v_cndmask_b32 v12, 0, v9, vcc
    v_cmp_eq_u32 vcc, 3, v8
    s_nop 1
    v_cndmask_b32 v13, 0, v9, vcc
    v_bfe_u32 v8, v0, 3, 1
    v_lshlrev_b32 v15, 9, v8
    v_lshl_add_u32 v15, v3, 6, v15
    v_and_b32 v8, 3, v0
    v_lshl_add_u32 v15, v8, 4, v15
    v_mov_b32 v92, 0xff800000
    v_mov_b32 v94, 0
    v_mov_b32 v93, 0xff800000
    v_mov_b32 v95, 0
    s_mov_b32 s96, 0x3db8aa3b
    s_mov_b32 s97, 0xffff0000
    s_waitcnt vmcnt(7)
    s_add_u32 s55, s52, 32768
    buffer_load_dwordx4 v[132:135], v4, s[40:43], s55 offen offset:0 nt
    s_waitcnt vmcnt(7)
    buffer_load_dwordx4 v[136:139], v4, s[40:43], s55 offen offset:256 nt
    s_waitcnt vmcnt(7)
    buffer_load_dwordx4 v[140:143], v4, s[40:43], s55 offen offset:512 nt
    s_waitcnt vmcnt(7)
    buffer_load_dwordx4 v[144:147], v4, s[40:43], s55 offen offset:768 nt
    s_waitcnt vmcnt(7)
    buffer_load_dwordx4 v[148:151], v4, s[40:43], s55 offen offset:1024 nt
    s_waitcnt vmcnt(7)
    buffer_load_dwordx4 v[152:155], v4, s[40:43], s55 offen offset:1280 nt
    s_waitcnt vmcnt(7)
    buffer_load_dwordx4 v[156:159], v4, s[40:43], s55 offen offset:1536 nt
    s_waitcnt vmcnt(7)
    buffer_load_dwordx4 v[160:163], v4, s[40:43], s55 offen offset:1792 nt
    s_waitcnt vmcnt(7)
    s_add_u32 s55, s52, 65536
    buffer_load_dwordx4 v[164:167], v4, s[40:43], s55 offen offset:0 nt
    s_waitcnt vmcnt(7)
    buffer_load_dwordx4 v[168:171], v4, s[40:43], s55 offen offset:256 nt
    s_waitcnt vmcnt(7)
    buffer_load_dwordx4 v[172:175], v4, s[40:43], s55 offen offset:512 nt
    s_waitcnt vmcnt(7)
    buffer_load_dwordx4 v[176:179], v4, s[40:43], s55 offen offset:768 nt
    s_waitcnt vmcnt(7)
    buffer_load_dwordx4 v[180:183], v4, s[40:43], s55 offen offset:1024 nt
    s_waitcnt vmcnt(7)
    buffer_load_dwordx4 v[184:187], v4, s[40:43], s55 offen offset:1280 nt
    s_waitcnt vmcnt(7)
    buffer_load_dwordx4 v[188:191], v4, s[40:43], s55 offen offset:1536 nt
    s_waitcnt vmcnt(7)
    buffer_load_dwordx4 v[192:195], v4, s[40:43], s55 offen offset:1792 nt
    s_waitcnt vmcnt(7)
    s_add_u32 s55, s52, 98304
    buffer_load_dwordx4 v[196:199], v4, s[40:43], s55 offen offset:0 nt
    s_waitcnt vmcnt(7)
    buffer_load_dwordx4 v[200:203], v4, s[40:43], s55 offen offset:256 nt
    s_waitcnt vmcnt(7)
    buffer_load_dwordx4 v[204:207], v4, s[40:43], s55 offen offset:512 nt
    s_waitcnt vmcnt(7)
    buffer_load_dwordx4 v[208:211], v4, s[40:43], s55 offen offset:768 nt
    s_waitcnt vmcnt(7)
    buffer_load_dwordx4 v[212:215], v4, s[40:43], s55 offen offset:1024 nt
    s_waitcnt vmcnt(7)
    buffer_load_dwordx4 v[216:219], v4, s[40:43], s55 offen offset:1280 nt
    s_waitcnt vmcnt(7)
    buffer_load_dwordx4 v[220:223], v4, s[40:43], s55 offen offset:1536 nt
    s_waitcnt vmcnt(7)
    buffer_load_dwordx4 v[224:227], v4, s[40:43], s55 offen offset:1792 nt
    s_waitcnt vmcnt(7)
    s_add_u32 s55, s52, 131072
    buffer_load_dwordx4 v[228:231], v4, s[40:43], s55 offen offset:0 nt
    s_waitcnt vmcnt(7)
    buffer_load_dwordx4 v[232:235], v4, s[40:43], s55 offen offset:256 nt
    s_waitcnt vmcnt(7)
    buffer_load_dwordx4 v[236:239], v4, s[40:43], s55 offen offset:512 nt
    s_waitcnt vmcnt(7)
    buffer_load_dwordx4 v[240:243], v4, s[40:43], s55 offen offset:768 nt
    s_waitcnt vmcnt(7)
    buffer_load_dwordx4 v[244:247], v4, s[40:43], s55 offen offset:1024 nt
    s_waitcnt vmcnt(7)
    buffer_load_dwordx4 v[248:251], v4, s[40:43], s55 offen offset:1280 nt
    s_waitcnt vmcnt(7)
    buffer_load_dwordx4 v[252:255], v4, s[40:43], s55 offen offset:1536 nt
    s_waitcnt lgkmcnt(0)
    s_add_u32 s30, s30, 0x3b5d7f91
    s_mov_b32 s56, 0x7060500
    s_mov_b32 s57, 0x7060501
    s_mov_b32 s58, 0x7060502
    s_mov_b32 s59, 0x7060503
    s_mov_b32 s60, 0x0c0c0400
    s_mov_b32 s61, 0x04000c0c
    v_mov_b32 v7, s30
    v_mov_b32 v8, 0
    s_mov_b32 s62, 1600000
L_qw:
    ds_read_b32 v9, v8 offset:18816
    s_waitcnt lgkmcnt(0)
    v_cmp_ne_u32 vcc, 0, v9
    s_cbranch_vccnz L_qw_done
    s_sub_u32 s62, s62, 1
    s_cbranch_scc1 L_qw_done
    s_sleep 1
    s_branch L_qw
L_qw_done:
    v_readfirstlane_b32 s69, v9
    ds_read_b128 v[16:19], v15 offset:0
    ds_read_b128 v[20:23], v15 offset:256
    ds_read_b128 v[24:27], v15 offset:1024
    ds_read_b128 v[28:31], v15 offset:1280
    s_waitcnt lgkmcnt(0)
    s_waitcnt vmcnt(38)
    v_mfma_f32_16x16x32_bf16 v[52:55], v[100:103], v[16:19], 0
    s_waitcnt vmcnt(37)
    v_mfma_f32_16x16x32_bf16 v[52:55], v[104:107], v[20:23], v[52:55]
    s_waitcnt vmcnt(4)
    buffer_load_dwordx4 v[100:103], v4, s[40:43], s55 offen offset:1792 nt
    s_waitcnt vmcnt(37)
    v_mfma_f32_16x16x32_bf16 v[56:59], v[108:111], v[16:19], 0
    s_waitcnt vmcnt(36)
    v_mfma_f32_16x16x32_bf16 v[56:59], v[112:115], v[20:23], v[56:59]
    s_waitcnt vmcnt(4)
    s_add_u32 s55, s52, 163840
    buffer_load_dwordx4 v[104:107], v4, s[40:43], s55 offen offset:0 nt
    s_waitcnt vmcnt(36)
    v_mfma_f32_16x16x32_bf16 v[60:63], v[116:119], v[16:19], 0
    s_waitcnt vmcnt(35)
    v_mfma_f32_16x16x32_bf16 v[60:63], v[120:123], v[20:23], v[60:63]
    s_waitcnt vmcnt(4)
    buffer_load_dwordx4 v[108:111], v4, s[40:43], s55 offen offset:256 nt
    v_mov_b32_dpp v96, v52 quad_perm:[0,0,0,0] row_mask:0xf bank_mask:0xf
    v_mov_b32_dpp v97, v54 quad_perm:[2,2,2,2] row_mask:0xf bank_mask:0xf
    v_mov_b32_dpp v98, v56 quad_perm:[0,0,0,0] row_mask:0xf bank_mask:0xf
    v_mov_b32_dpp v99, v58 quad_perm:[2,2,2,2] row_mask:0xf bank_mask:0xf
    v_add_f32_dpp v96, v53, v96 quad_perm:[1,1,1,1] row_mask:0xf bank_mask:0xf
    v_add_f32_dpp v97, v55, v97 quad_perm:[3,3,3,3] row_mask:0xf bank_mask:0xf
    v_add_f32_dpp v98, v57, v98 quad_perm:[1,1,1,1] row_mask:0xf bank_mask:0xf
    v_add_f32_dpp v99, v59, v99 quad_perm:[3,3,3,3] row_mask:0xf bank_mask:0xf
    v_add_f32 v96, v96, v97
    v_add_f32 v98, v98, v99
    v_cvt_pk_bf16_f32 v32, v96, v98
    v_lshlrev_b32 v96, 16, v32
    v_and_b32 v97, s97, v32
    v_max3_f32 v92, v96, v97, v92
    s_waitcnt vmcnt(35)
    v_mfma_f32_16x16x32_bf16 v[64:67], v[124:127], v[16:19], 0
    s_waitcnt vmcnt(34)
    v_mfma_f32_16x16x32_bf16 v[64:67], v[128:131], v[20:23], v[64:67]
    s_waitcnt vmcnt(4)
    buffer_load_dwordx4 v[112:115], v4, s[40:43], s55 offen offset:512 nt
    s_waitcnt vmcnt(34)
    v_mfma_f32_16x16x32_bf16 v[52:55], v[132:135], v[16:19], 0
    s_waitcnt vmcnt(33)
    v_mfma_f32_16x16x32_bf16 v[52:55], v[136:139], v[20:23], v[52:55]
    s_waitcnt vmcnt(4)
    buffer_load_dwordx4 v[116:119], v4, s[40:43], s55 offen offset:768 nt
    v_mov_b32_dpp v96, v60 quad_perm:[0,0,0,0] row_mask:0xf bank_mask:0xf
    v_mov_b32_dpp v97, v62 quad_perm:[2,2,2,2] row_mask:0xf bank_mask:0xf
    v_mov_b32_dpp v98, v64 quad_perm:[0,0,0,0] row_mask:0xf bank_mask:0xf
    v_mov_b32_dpp v99, v66 quad_perm:[2,2,2,2] row_mask:0xf bank_mask:0xf
    v_add_f32_dpp v96, v61, v96 quad_perm:[1,1,1,1] row_mask:0xf bank_mask:0xf
    v_add_f32_dpp v97, v63, v97 quad_perm:[3,3,3,3] row_mask:0xf bank_mask:0xf
    v_add_f32_dpp v98, v65, v98 quad_perm:[1,1,1,1] row_mask:0xf bank_mask:0xf
    v_add_f32_dpp v99, v67, v99 quad_perm:[3,3,3,3] row_mask:0xf bank_mask:0xf
    v_add_f32 v96, v96, v97
    v_add_f32 v98, v98, v99
    v_cvt_pk_bf16_f32 v33, v96, v98
    v_lshlrev_b32 v96, 16, v33
    v_and_b32 v97, s97, v33
    v_max3_f32 v92, v96, v97, v92
    s_waitcnt vmcnt(33)
    v_mfma_f32_16x16x32_bf16 v[56:59], v[140:143], v[16:19], 0
    s_waitcnt vmcnt(32)
    v_mfma_f32_16x16x32_bf16 v[56:59], v[144:147], v[20:23], v[56:59]
    s_waitcnt vmcnt(4)
    buffer_load_dwordx4 v[120:123], v4, s[40:43], s55 offen offset:1024 nt
    s_waitcnt vmcnt(32)
    v_mfma_f32_16x16x32_bf16 v[60:63], v[148:151], v[16:19], 0
    s_waitcnt vmcnt(31)
    v_mfma_f32_16x16x32_bf16 v[60:63], v[152:155], v[20:23], v[60:63]
    s_waitcnt vmcnt(4)
    buffer_load_dwordx4 v[124:127], v4, s[40:43], s55 offen offset:1280 nt
    v_mov_b32_dpp v96, v52 quad_perm:[0,0,0,0] row_mask:0xf bank_mask:0xf
    v_mov_b32_dpp v97, v54 quad_perm:[2,2,2,2] row_mask:0xf bank_mask:0xf
    v_mov_b32_dpp v98, v56 quad_perm:[0,0,0,0] row_mask:0xf bank_mask:0xf
    v_mov_b32_dpp v99, v58 quad_perm:[2,2,2,2] row_mask:0xf bank_mask:0xf
    v_add_f32_dpp v96, v53, v96 quad_perm:[1,1,1,1] row_mask:0xf bank_mask:0xf
    v_add_f32_dpp v97, v55, v97 quad_perm:[3,3,3,3] row_mask:0xf bank_mask:0xf
    v_add_f32_dpp v98, v57, v98 quad_perm:[1,1,1,1] row_mask:0xf bank_mask:0xf
    v_add_f32_dpp v99, v59, v99 quad_perm:[3,3,3,3] row_mask:0xf bank_mask:0xf
    v_add_f32 v96, v96, v97
    v_add_f32 v98, v98, v99
    v_cvt_pk_bf16_f32 v34, v96, v98
    v_lshlrev_b32 v96, 16, v34
    v_and_b32 v97, s97, v34
    v_max3_f32 v92, v96, v97, v92
    s_waitcnt vmcnt(31)
    v_mfma_f32_16x16x32_bf16 v[64:67], v[156:159], v[16:19], 0
    s_waitcnt vmcnt(30)
    v_mfma_f32_16x16x32_bf16 v[64:67], v[160:163], v[20:23], v[64:67]
    s_waitcnt vmcnt(4)
    buffer_load_dwordx4 v[128:131], v4, s[40:43], s55 offen offset:1536 nt
    s_waitcnt vmcnt(30)
    v_mfma_f32_16x16x32_bf16 v[52:55], v[164:167], v[16:19], 0
    s_waitcnt vmcnt(29)
    v_mfma_f32_16x16x32_bf16 v[52:55], v[168:171], v[20:23], v[52:55]
    s_waitcnt vmcnt(4)
    buffer_load_dwordx4 v[132:135], v4, s[40:43], s55 offen offset:1792 nt
    v_mov_b32_dpp v96, v60 quad_perm:[0,0,0,0] row_mask:0xf bank_mask:0xf
    v_mov_b32_dpp v97, v62 quad_perm:[2,2,2,2] row_mask:0xf bank_mask:0xf
    v_mov_b32_dpp v98, v64 quad_perm:[0,0,0,0] row_mask:0xf bank_mask:0xf
    v_mov_b32_dpp v99, v66 quad_perm:[2,2,2,2] row_mask:0xf bank_mask:0xf
    v_add_f32_dpp v96, v61, v96 quad_perm:[1,1,1,1] row_mask:0xf bank_mask:0xf
    v_add_f32_dpp v97, v63, v97 quad_perm:[3,3,3,3] row_mask:0xf bank_mask:0xf
    v_add_f32_dpp v98, v65, v98 quad_perm:[1,1,1,1] row_mask:0xf bank_mask:0xf
    v_add_f32_dpp v99, v67, v99 quad_perm:[3,3,3,3] row_mask:0xf bank_mask:0xf
    v_add_f32 v96, v96, v97
    v_add_f32 v98, v98, v99
    v_cvt_pk_bf16_f32 v35, v96, v98
    v_lshlrev_b32 v96, 16, v35
    v_and_b32 v97, s97, v35
    v_max3_f32 v92, v96, v97, v92
    s_waitcnt vmcnt(29)
    v_mfma_f32_16x16x32_bf16 v[56:59], v[172:175], v[16:19], 0
    s_waitcnt vmcnt(28)
    v_mfma_f32_16x16x32_bf16 v[56:59], v[176:179], v[20:23], v[56:59]
    s_waitcnt vmcnt(4)
    s_add_u32 s55, s52, 196608
    buffer_load_dwordx4 v[136:139], v4, s[40:43], s55 offen offset:0 nt
    s_waitcnt vmcnt(28)
    v_mfma_f32_16x16x32_bf16 v[60:63], v[180:183], v[16:19], 0
    s_waitcnt vmcnt(27)
    v_mfma_f32_16x16x32_bf16 v[60:63], v[184:187], v[20:23], v[60:63]
    s_waitcnt vmcnt(4)
    buffer_load_dwordx4 v[140:143], v4, s[40:43], s55 offen offset:256 nt
    v_mov_b32_dpp v96, v52 quad_perm:[0,0,0,0] row_mask:0xf bank_mask:0xf
    v_mov_b32_dpp v97, v54 quad_perm:[2,2,2,2] row_mask:0xf bank_mask:0xf
    v_mov_b32_dpp v98, v56 quad_perm:[0,0,0,0] row_mask:0xf bank_mask:0xf
    v_mov_b32_dpp v99, v58 quad_perm:[2,2,2,2] row_mask:0xf bank_mask:0xf
    v_add_f32_dpp v96, v53, v96 quad_perm:[1,1,1,1] row_mask:0xf bank_mask:0xf
    v_add_f32_dpp v97, v55, v97 quad_perm:[3,3,3,3] row_mask:0xf bank_mask:0xf
    v_add_f32_dpp v98, v57, v98 quad_perm:[1,1,1,1] row_mask:0xf bank_mask:0xf
    v_add_f32_dpp v99, v59, v99 quad_perm:[3,3,3,3] row_mask:0xf bank_mask:0xf
    v_add_f32 v96, v96, v97
    v_add_f32 v98, v98, v99
    v_cvt_pk_bf16_f32 v36, v96, v98
    v_lshlrev_b32 v96, 16, v36
    v_and_b32 v97, s97, v36
    v_max3_f32 v92, v96, v97, v92
    s_waitcnt vmcnt(27)
    v_mfma_f32_16x16x32_bf16 v[64:67], v[188:191], v[16:19], 0
    s_waitcnt vmcnt(26)
    v_mfma_f32_16x16x32_bf16 v[64:67], v[192:195], v[20:23], v[64:67]
    s_waitcnt vmcnt(4)
    buffer_load_dwordx4 v[144:147], v4, s[40:43], s55 offen offset:512 nt
    s_waitcnt vmcnt(26)
    v_mfma_f32_16x16x32_bf16 v[52:55], v[196:199], v[16:19], 0
    s_waitcnt vmcnt(25)
    v_mfma_f32_16x16x32_bf16 v[52:55], v[200:203], v[20:23], v[52:55]
    s_waitcnt vmcnt(4)
    buffer_load_dwordx4 v[148:151], v4, s[40:43], s55 offen offset:768 nt
    v_mov_b32_dpp v96, v60 quad_perm:[0,0,0,0] row_mask:0xf bank_mask:0xf
    v_mov_b32_dpp v97, v62 quad_perm:[2,2,2,2] row_mask:0xf bank_mask:0xf
    v_mov_b32_dpp v98, v64 quad_perm:[0,0,0,0] row_mask:0xf bank_mask:0xf
    v_mov_b32_dpp v99, v66 quad_perm:[2,2,2,2] row_mask:0xf bank_mask:0xf
    v_add_f32_dpp v96, v61, v96 quad_perm:[1,1,1,1] row_mask:0xf bank_mask:0xf
    v_add_f32_dpp v97, v63, v97 quad_perm:[3,3,3,3] row_mask:0xf bank_mask:0xf
    v_add_f32_dpp v98, v65, v98 quad_perm:[1,1,1,1] row_mask:0xf bank_mask:0xf
    v_add_f32_dpp v99, v67, v99 quad_perm:[3,3,3,3] row_mask:0xf bank_mask:0xf
    v_add_f32 v96, v96, v97
    v_add_f32 v98, v98, v99
    v_cvt_pk_bf16_f32 v37, v96, v98
    v_lshlrev_b32 v96, 16, v37
    v_and_b32 v97, s97, v37
    v_max3_f32 v92, v96, v97, v92
    s_waitcnt vmcnt(25)
    v_mfma_f32_16x16x32_bf16 v[56:59], v[204:207], v[16:19], 0
    s_waitcnt vmcnt(24)
    v_mfma_f32_16x16x32_bf16 v[56:59], v[208:211], v[20:23], v[56:59]
    s_waitcnt vmcnt(4)
    buffer_load_dwordx4 v[152:155], v4, s[40:43], s55 offen offset:1024 nt
    s_waitcnt vmcnt(24)
    v_mfma_f32_16x16x32_bf16 v[60:63], v[212:215], v[16:19], 0
    s_waitcnt vmcnt(23)
    v_mfma_f32_16x16x32_bf16 v[60:63], v[216:219], v[20:23], v[60:63]
    s_waitcnt vmcnt(4)
    buffer_load_dwordx4 v[156:159], v4, s[40:43], s55 offen offset:1280 nt
    v_mov_b32_dpp v96, v52 quad_perm:[0,0,0,0] row_mask:0xf bank_mask:0xf
    v_mov_b32_dpp v97, v54 quad_perm:[2,2,2,2] row_mask:0xf bank_mask:0xf
    v_mov_b32_dpp v98, v56 quad_perm:[0,0,0,0] row_mask:0xf bank_mask:0xf
    v_mov_b32_dpp v99, v58 quad_perm:[2,2,2,2] row_mask:0xf bank_mask:0xf
    v_add_f32_dpp v96, v53, v96 quad_perm:[1,1,1,1] row_mask:0xf bank_mask:0xf
    v_add_f32_dpp v97, v55, v97 quad_perm:[3,3,3,3] row_mask:0xf bank_mask:0xf
    v_add_f32_dpp v98, v57, v98 quad_perm:[1,1,1,1] row_mask:0xf bank_mask:0xf
    v_add_f32_dpp v99, v59, v99 quad_perm:[3,3,3,3] row_mask:0xf bank_mask:0xf
    v_add_f32 v96, v96, v97
    v_add_f32 v98, v98, v99
    v_cvt_pk_bf16_f32 v38, v96, v98
    v_lshlrev_b32 v96, 16, v38
    v_and_b32 v97, s97, v38
    v_max3_f32 v92, v96, v97, v92
    s_waitcnt vmcnt(23)
    v_mfma_f32_16x16x32_bf16 v[64:67], v[220:223], v[16:19], 0
    s_waitcnt vmcnt(22)
    v_mfma_f32_16x16x32_bf16 v[64:67], v[224:227], v[20:23], v[64:67]
    s_waitcnt vmcnt(4)
    buffer_load_dwordx4 v[160:163], v4, s[40:43], s55 offen offset:1536 nt
    s_waitcnt vmcnt(22)
    v_mfma_f32_16x16x32_bf16 v[52:55], v[228:231], v[16:19], 0
    s_waitcnt vmcnt(21)
    v_mfma_f32_16x16x32_bf16 v[52:55], v[232:235], v[20:23], v[52:55]
    s_waitcnt vmcnt(4)
    buffer_load_dwordx4 v[164:167], v4, s[40:43], s55 offen offset:1792 nt
    v_mov_b32_dpp v96, v60 quad_perm:[0,0,0,0] row_mask:0xf bank_mask:0xf
    v_mov_b32_dpp v97, v62 quad_perm:[2,2,2,2] row_mask:0xf bank_mask:0xf
    v_mov_b32_dpp v98, v64 quad_perm:[0,0,0,0] row_mask:0xf bank_mask:0xf
    v_mov_b32_dpp v99, v66 quad_perm:[2,2,2,2] row_mask:0xf bank_mask:0xf
    v_add_f32_dpp v96, v61, v96 quad_perm:[1,1,1,1] row_mask:0xf bank_mask:0xf
    v_add_f32_dpp v97, v63, v97 quad_perm:[3,3,3,3] row_mask:0xf bank_mask:0xf
    v_add_f32_dpp v98, v65, v98 quad_perm:[1,1,1,1] row_mask:0xf bank_mask:0xf
    v_add_f32_dpp v99, v67, v99 quad_perm:[3,3,3,3] row_mask:0xf bank_mask:0xf
    v_add_f32 v96, v96, v97
    v_add_f32 v98, v98, v99
    v_cvt_pk_bf16_f32 v39, v96, v98
    v_lshlrev_b32 v96, 16, v39
    v_and_b32 v97, s97, v39
    v_max3_f32 v92, v96, v97, v92
    s_waitcnt vmcnt(21)
    v_mfma_f32_16x16x32_bf16 v[56:59], v[236:239], v[16:19], 0
    s_waitcnt vmcnt(20)
    v_mfma_f32_16x16x32_bf16 v[56:59], v[240:243], v[20:23], v[56:59]
    s_waitcnt vmcnt(4)
    s_add_u32 s55, s52, 229376
    buffer_load_dwordx4 v[168:171], v4, s[40:43], s55 offen offset:0 nt
    s_waitcnt vmcnt(20)
    v_mfma_f32_16x16x32_bf16 v[60:63], v[244:247], v[16:19], 0
    s_waitcnt vmcnt(19)
    v_mfma_f32_16x16x32_bf16 v[60:63], v[248:251], v[20:23], v[60:63]
    s_waitcnt vmcnt(4)
    buffer_load_dwordx4 v[172:175], v4, s[40:43], s55 offen offset:256 nt
    v_mov_b32_dpp v96, v52 quad_perm:[0,0,0,0] row_mask:0xf bank_mask:0xf
    v_mov_b32_dpp v97, v54 quad_perm:[2,2,2,2] row_mask:0xf bank_mask:0xf
    v_mov_b32_dpp v98, v56 quad_perm:[0,0,0,0] row_mask:0xf bank_mask:0xf
    v_mov_b32_dpp v99, v58 quad_perm:[2,2,2,2] row_mask:0xf bank_mask:0xf
    v_add_f32_dpp v96, v53, v96 quad_perm:[1,1,1,1] row_mask:0xf bank_mask:0xf
    v_add_f32_dpp v97, v55, v97 quad_perm:[3,3,3,3] row_mask:0xf bank_mask:0xf
    v_add_f32_dpp v98, v57, v98 quad_perm:[1,1,1,1] row_mask:0xf bank_mask:0xf
    v_add_f32_dpp v99, v59, v99 quad_perm:[3,3,3,3] row_mask:0xf bank_mask:0xf
    v_add_f32 v96, v96, v97
    v_add_f32 v98, v98, v99
    v_cvt_pk_bf16_f32 v40, v96, v98
    v_lshlrev_b32 v96, 16, v40
    v_and_b32 v97, s97, v40
    v_max3_f32 v92, v96, v97, v92
    s_waitcnt vmcnt(19)
    v_mfma_f32_16x16x32_bf16 v[64:67], v[252:255], v[16:19], 0
    s_waitcnt vmcnt(18)
    v_mfma_f32_16x16x32_bf16 v[64:67], v[100:103], v[20:23], v[64:67]
    s_waitcnt vmcnt(4)
    buffer_load_dwordx4 v[176:179], v4, s[40:43], s55 offen offset:512 nt
    s_waitcnt vmcnt(18)
    v_mfma_f32_16x16x32_bf16 v[52:55], v[104:107], v[16:19], 0
    s_waitcnt vmcnt(17)
    v_mfma_f32_16x16x32_bf16 v[52:55], v[108:111], v[20:23], v[52:55]
    s_waitcnt vmcnt(4)
    buffer_load_dwordx4 v[180:183], v4, s[40:43], s55 offen offset:768 nt
    v_mov_b32_dpp v96, v60 quad_perm:[0,0,0,0] row_mask:0xf bank_mask:0xf
    v_mov_b32_dpp v97, v62 quad_perm:[2,2,2,2] row_mask:0xf bank_mask:0xf
    v_mov_b32_dpp v98, v64 quad_perm:[0,0,0,0] row_mask:0xf bank_mask:0xf
    v_mov_b32_dpp v99, v66 quad_perm:[2,2,2,2] row_mask:0xf bank_mask:0xf
    v_add_f32_dpp v96, v61, v96 quad_perm:[1,1,1,1] row_mask:0xf bank_mask:0xf
    v_add_f32_dpp v97, v63, v97 quad_perm:[3,3,3,3] row_mask:0xf bank_mask:0xf
    v_add_f32_dpp v98, v65, v98 quad_perm:[1,1,1,1] row_mask:0xf bank_mask:0xf
    v_add_f32_dpp v99, v67, v99 quad_perm:[3,3,3,3] row_mask:0xf bank_mask:0xf
    v_add_f32 v96, v96, v97
    v_add_f32 v98, v98, v99
    v_cvt_pk_bf16_f32 v41, v96, v98
    v_lshlrev_b32 v96, 16, v41
    v_and_b32 v97, s97, v41
    v_max3_f32 v92, v96, v97, v92
    s_waitcnt vmcnt(17)
    v_mfma_f32_16x16x32_bf16 v[56:59], v[112:115], v[16:19], 0
    s_waitcnt vmcnt(16)
    v_mfma_f32_16x16x32_bf16 v[56:59], v[116:119], v[20:23], v[56:59]
    s_waitcnt vmcnt(4)
    buffer_load_dwordx4 v[184:187], v4, s[40:43], s55 offen offset:1024 nt
    s_waitcnt vmcnt(16)
    v_mfma_f32_16x16x32_bf16 v[60:63], v[120:123], v[16:19], 0
    s_waitcnt vmcnt(15)
    v_mfma_f32_16x16x32_bf16 v[60:63], v[124:127], v[20:23], v[60:63]
    s_waitcnt vmcnt(4)
    buffer_load_dwordx4 v[188:191], v4, s[40:43], s55 offen offset:1280 nt
    v_mov_b32_dpp v96, v52 quad_perm:[0,0,0,0] row_mask:0xf bank_mask:0xf
    v_mov_b32_dpp v97, v54 quad_perm:[2,2,2,2] row_mask:0xf bank_mask:0xf
    v_mov_b32_dpp v98, v56 quad_perm:[0,0,0,0] row_mask:0xf bank_mask:0xf
    v_mov_b32_dpp v99, v58 quad_perm:[2,2,2,2] row_mask:0xf bank_mask:0xf
    v_add_f32_dpp v96, v53, v96 quad_perm:[1,1,1,1] row_mask:0xf bank_mask:0xf
    v_add_f32_dpp v97, v55, v97 quad_perm:[3,3,3,3] row_mask:0xf bank_mask:0xf
    v_add_f32_dpp v98, v57, v98 quad_perm:[1,1,1,1] row_mask:0xf bank_mask:0xf
    v_add_f32_dpp v99, v59, v99 quad_perm:[3,3,3,3] row_mask:0xf bank_mask:0xf
    v_add_f32 v96, v96, v97
    v_add_f32 v98, v98, v99
    v_cvt_pk_bf16_f32 v42, v96, v98
    v_lshlrev_b32 v96, 16, v42
    v_and_b32 v97, s97, v42
    v_max3_f32 v92, v96, v97, v92
    s_waitcnt vmcnt(15)
    v_mfma_f32_16x16x32_bf16 v[64:67], v[128:131], v[16:19], 0
    s_waitcnt vmcnt(14)
    v_mfma_f32_16x16x32_bf16 v[64:67], v[132:135], v[20:23], v[64:67]
    s_waitcnt vmcnt(4)
    buffer_load_dwordx4 v[192:195], v4, s[40:43], s55 offen offset:1536 nt
    s_waitcnt vmcnt(14)
    v_mfma_f32_16x16x32_bf16 v[52:55], v[136:139], v[16:19], 0
    s_waitcnt vmcnt(13)
    v_mfma_f32_16x16x32_bf16 v[52:55], v[140:143], v[20:23], v[52:55]
    s_waitcnt vmcnt(4)
    buffer_load_dwordx4 v[196:199], v4, s[40:43], s55 offen offset:1792 nt
    v_mov_b32_dpp v96, v60 quad_perm:[0,0,0,0] row_mask:0xf bank_mask:0xf
    v_mov_b32_dpp v97, v62 quad_perm:[2,2,2,2] row_mask:0xf bank_mask:0xf
    v_mov_b32_dpp v98, v64 quad_perm:[0,0,0,0] row_mask:0xf bank_mask:0xf
    v_mov_b32_dpp v99, v66 quad_perm:[2,2,2,2] row_mask:0xf bank_mask:0xf
    v_add_f32_dpp v96, v61, v96 quad_perm:[1,1,1,1] row_mask:0xf bank_mask:0xf
    v_add_f32_dpp v97, v63, v97 quad_perm:[3,3,3,3] row_mask:0xf bank_mask:0xf
    v_add_f32_dpp v98, v65, v98 quad_perm:[1,1,1,1] row_mask:0xf bank_mask:0xf
    v_add_f32_dpp v99, v67, v99 quad_perm:[3,3,3,3] row_mask:0xf bank_mask:0xf
    v_add_f32 v96, v96, v97
    v_add_f32 v98, v98, v99
    v_cvt_pk_bf16_f32 v43, v96, v98
    v_lshlrev_b32 v96, 16, v43
    v_and_b32 v97, s97, v43
    v_max3_f32 v92, v96, v97, v92
    s_waitcnt vmcnt(13)
    v_mfma_f32_16x16x32_bf16 v[56:59], v[144:147], v[16:19], 0
    s_waitcnt vmcnt(12)
    v_mfma_f32_16x16x32_bf16 v[56:59], v[148:151], v[20:23], v[56:59]
    s_waitcnt vmcnt(4)
    s_add_u32 s55, s53, 0
    buffer_load_dwordx4 v[200:203], v4, s[48:51], s55 offen offset:0 nt
    s_waitcnt vmcnt(12)
    v_mfma_f32_16x16x32_bf16 v[60:63], v[152:155], v[16:19], 0
    s_waitcnt vmcnt(11)
    v_mfma_f32_16x16x32_bf16 v[60:63], v[156:159], v[20:23], v[60:63]
    s_waitcnt vmcnt(4)
    buffer_load_dwordx4 v[204:207], v4, s[48:51], s55 offen offset:256 nt
    v_mov_b32_dpp v96, v52 quad_perm:[0,0,0,0] row_mask:0xf bank_mask:0xf
    v_mov_b32_dpp v97, v54 quad_perm:[2,2,2,2] row_mask:0xf bank_mask:0xf
    v_mov_b32_dpp v98, v56 quad_perm:[0,0,0,0] row_mask:0xf bank_mask:0xf
    v_mov_b32_dpp v99, v58 quad_perm:[2,2,2,2] row_mask:0xf bank_mask:0xf
    v_add_f32_dpp v96, v53, v96 quad_perm:[1,1,1,1] row_mask:0xf bank_mask:0xf
    v_add_f32_dpp v97, v55, v97 quad_perm:[3,3,3,3] row_mask:0xf bank_mask:0xf
    v_add_f32_dpp v98, v57, v98 quad_perm:[1,1,1,1] row_mask:0xf bank_mask:0xf
    v_add_f32_dpp v99, v59, v99 quad_perm:[3,3,3,3] row_mask:0xf bank_mask:0xf
    v_add_f32 v96, v96, v97
    v_add_f32 v98, v98, v99
    v_cvt_pk_bf16_f32 v44, v96, v98
    v_lshlrev_b32 v96, 16, v44
    v_and_b32 v97, s97, v44
    v_max3_f32 v92, v96, v97, v92
    s_waitcnt vmcnt(11)
    v_mfma_f32_16x16x32_bf16 v[64:67], v[160:163], v[16:19], 0
    s_waitcnt vmcnt(10)
    v_mfma_f32_16x16x32_bf16 v[64:67], v[164:167], v[20:23], v[64:67]
    s_waitcnt vmcnt(4)
    buffer_load_dwordx4 v[208:211], v4, s[48:51], s55 offen offset:512 nt
    s_waitcnt vmcnt(10)
    v_mfma_f32_16x16x32_bf16 v[52:55], v[168:171], v[16:19], 0
    s_waitcnt vmcnt(9)
    v_mfma_f32_16x16x32_bf16 v[52:55], v[172:175], v[20:23], v[52:55]
    s_waitcnt vmcnt(4)
    buffer_load_dwordx4 v[212:215], v4, s[48:51], s55 offen offset:768 nt
    v_mov_b32_dpp v96, v60 quad_perm:[0,0,0,0] row_mask:0xf bank_mask:0xf
    v_mov_b32_dpp v97, v62 quad_perm:[2,2,2,2] row_mask:0xf bank_mask:0xf
    v_mov_b32_dpp v98, v64 quad_perm:[0,0,0,0] row_mask:0xf bank_mask:0xf
    v_mov_b32_dpp v99, v66 quad_perm:[2,2,2,2] row_mask:0xf bank_mask:0xf
    v_add_f32_dpp v96, v61, v96 quad_perm:[1,1,1,1] row_mask:0xf bank_mask:0xf
    v_add_f32_dpp v97, v63, v97 quad_perm:[3,3,3,3] row_mask:0xf bank_mask:0xf
    v_add_f32_dpp v98, v65, v98 quad_perm:[1,1,1,1] row_mask:0xf bank_mask:0xf
    v_add_f32_dpp v99, v67, v99 quad_perm:[3,3,3,3] row_mask:0xf bank_mask:0xf
    v_add_f32 v96, v96, v97
    v_add_f32 v98, v98, v99
    v_cvt_pk_bf16_f32 v45, v96, v98
    v_lshlrev_b32 v96, 16, v45
    v_and_b32 v97, s97, v45
    v_max3_f32 v92, v96, v97, v92
    s_waitcnt vmcnt(9)
    v_mfma_f32_16x16x32_bf16 v[56:59], v[176:179], v[16:19], 0
    s_waitcnt vmcnt(8)
    v_mfma_f32_16x16x32_bf16 v[56:59], v[180:183], v[20:23], v[56:59]
    s_waitcnt vmcnt(4)
    buffer_load_dwordx4 v[216:219], v4, s[48:51], s55 offen offset:1024 nt
    s_waitcnt vmcnt(8)
    v_mfma_f32_16x16x32_bf16 v[60:63], v[184:187], v[16:19], 0
    s_waitcnt vmcnt(7)
    v_mfma_f32_16x16x32_bf16 v[60:63], v[188:191], v[20:23], v[60:63]
    s_waitcnt vmcnt(4)
    buffer_load_dwordx4 v[220:223], v4, s[48:51], s55 offen offset:1280 nt
    v_mov_b32_dpp v96, v52 quad_perm:[0,0,0,0] row_mask:0xf bank_mask:0xf
    v_mov_b32_dpp v97, v54 quad_perm:[2,2,2,2] row_mask:0xf bank_mask:0xf
    v_mov_b32_dpp v98, v56 quad_perm:[0,0,0,0] row_mask:0xf bank_mask:0xf
    v_mov_b32_dpp v99, v58 quad_perm:[2,2,2,2] row_mask:0xf bank_mask:0xf
    v_add_f32_dpp v96, v53, v96 quad_perm:[1,1,1,1] row_mask:0xf bank_mask:0xf
    v_add_f32_dpp v97, v55, v97 quad_perm:[3,3,3,3] row_mask:0xf bank_mask:0xf
    v_add_f32_dpp v98, v57, v98 quad_perm:[1,1,1,1] row_mask:0xf bank_mask:0xf
    v_add_f32_dpp v99, v59, v99 quad_perm:[3,3,3,3] row_mask:0xf bank_mask:0xf
    v_add_f32 v96, v96, v97
    v_add_f32 v98, v98, v99
    v_cvt_pk_bf16_f32 v46, v96, v98
    v_lshlrev_b32 v96, 16, v46
    v_and_b32 v97, s97, v46
    v_max3_f32 v92, v96, v97, v92
    s_waitcnt vmcnt(7)
    v_mfma_f32_16x16x32_bf16 v[64:67], v[192:195], v[16:19], 0
    s_waitcnt vmcnt(6)
    v_mfma_f32_16x16x32_bf16 v[64:67], v[196:199], v[20:23], v[64:67]
    s_waitcnt vmcnt(4)
    buffer_load_dwordx4 v[224:227], v4, s[48:51], s55 offen offset:1536 nt
    s_waitcnt vmcnt(6)
    v_mfma_f32_16x16x32_bf16 v[52:55], v[200:203], v[24:27], 0
    s_waitcnt vmcnt(5)
    v_mfma_f32_16x16x32_bf16 v[52:55], v[204:207], v[28:31], v[52:55]
    s_waitcnt vmcnt(4)
    buffer_load_dwordx4 v[228:231], v4, s[48:51], s55 offen offset:1792 nt
    v_mov_b32_dpp v96, v60 quad_perm:[0,0,0,0] row_mask:0xf bank_mask:0xf
    v_mov_b32_dpp v97, v62 quad_perm:[2,2,2,2] row_mask:0xf bank_mask:0xf
    v_mov_b32_dpp v98, v64 quad_perm:[0,0,0,0] row_mask:0xf bank_mask:0xf
    v_mov_b32_dpp v99, v66 quad_perm:[2,2,2,2] row_mask:0xf bank_mask:0xf
    v_add_f32_dpp v96, v61, v96 quad_perm:[1,1,1,1] row_mask:0xf bank_mask:0xf
    v_add_f32_dpp v97, v63, v97 quad_perm:[3,3,3,3] row_mask:0xf bank_mask:0xf
    v_add_f32_dpp v98, v65, v98 quad_perm:[1,1,1,1] row_mask:0xf bank_mask:0xf
    v_add_f32_dpp v99, v67, v99 quad_perm:[3,3,3,3] row_mask:0xf bank_mask:0xf
    v_add_f32 v96, v96, v97
    v_add_f32 v98, v98, v99
    v_cvt_pk_bf16_f32 v47, v96, v98
    v_lshlrev_b32 v96, 16, v47
    v_and_b32 v97, s97, v47
    v_max3_f32 v92, v96, v97, v92
    s_waitcnt vmcnt(5)
    v_mfma_f32_16x16x32_bf16 v[56:59], v[208:211], v[24:27], 0
    s_waitcnt vmcnt(4)
    v_mfma_f32_16x16x32_bf16 v[56:59], v[212:215], v[28:31], v[56:59]
    s_add_u32 s55, s53, 32768
    buffer_load_dwordx4 v[232:235], v4, s[48:51], s55 offen offset:0 nt
    s_waitcnt vmcnt(4)
    v_mfma_f32_16x16x32_bf16 v[60:63], v[216:219], v[24:27], 0
    buffer_load_dwordx4 v[236:239], v4, s[48:51], s55 offen offset:256 nt
    s_waitcnt vmcnt(4)
    v_mfma_f32_16x16x32_bf16 v[60:63], v[220:223], v[28:31], v[60:63]
    buffer_load_dwordx4 v[240:243], v4, s[48:51], s55 offen offset:512 nt
    v_mov_b32_dpp v96, v52 quad_perm:[0,0,0,0] row_mask:0xf bank_mask:0xf
    v_mov_b32_dpp v97, v54 quad_perm:[2,2,2,2] row_mask:0xf bank_mask:0xf
    v_mov_b32_dpp v98, v56 quad_perm:[0,0,0,0] row_mask:0xf bank_mask:0xf
    v_mov_b32_dpp v99, v58 quad_perm:[2,2,2,2] row_mask:0xf bank_mask:0xf
    v_add_f32_dpp v96, v53, v96 quad_perm:[1,1,1,1] row_mask:0xf bank_mask:0xf
    v_add_f32_dpp v97, v55, v97 quad_perm:[3,3,3,3] row_mask:0xf bank_mask:0xf
    v_add_f32_dpp v98, v57, v98 quad_perm:[1,1,1,1] row_mask:0xf bank_mask:0xf
    v_add_f32_dpp v99, v59, v99 quad_perm:[3,3,3,3] row_mask:0xf bank_mask:0xf
    v_add_f32 v96, v96, v97
    v_add_f32 v98, v98, v99
    v_cvt_pk_bf16_f32 v48, v96, v98
    v_lshlrev_b32 v96, 16, v48
    v_and_b32 v97, s97, v48
    v_max3_f32 v93, v96, v97, v93
    s_waitcnt vmcnt(4)
    v_mfma_f32_16x16x32_bf16 v[64:67], v[224:227], v[24:27], 0
    buffer_load_dwordx4 v[244:247], v4, s[48:51], s55 offen offset:768 nt
    s_waitcnt vmcnt(4)
    v_mfma_f32_16x16x32_bf16 v[64:67], v[228:231], v[28:31], v[64:67]
    buffer_load_dwordx4 v[248:251], v4, s[48:51], s55 offen offset:1024 nt
    s_waitcnt vmcnt(4)
    v_mfma_f32_16x16x32_bf16 v[52:55], v[232:235], v[24:27], 0
    buffer_load_dwordx4 v[252:255], v4, s[48:51], s55 offen offset:1280 nt
    s_waitcnt vmcnt(4)
    v_mfma_f32_16x16x32_bf16 v[52:55], v[236:239], v[28:31], v[52:55]
    buffer_load_dwordx4 v[100:103], v4, s[48:51], s55 offen offset:1536 nt
    v_mov_b32_dpp v96, v60 quad_perm:[0,0,0,0] row_mask:0xf bank_mask:0xf
    v_mov_b32_dpp v97, v62 quad_perm:[2,2,2,2] row_mask:0xf bank_mask:0xf
    v_mov_b32_dpp v98, v64 quad_perm:[0,0,0,0] row_mask:0xf bank_mask:0xf
    v_mov_b32_dpp v99, v66 quad_perm:[2,2,2,2] row_mask:0xf bank_mask:0xf
    v_add_f32_dpp v96, v61, v96 quad_perm:[1,1,1,1] row_mask:0xf bank_mask:0xf
    v_add_f32_dpp v97, v63, v97 quad_perm:[3,3,3,3] row_mask:0xf bank_mask:0xf
    v_add_f32_dpp v98, v65, v98 quad_perm:[1,1,1,1] row_mask:0xf bank_mask:0xf
    v_add_f32_dpp v99, v67, v99 quad_perm:[3,3,3,3] row_mask:0xf bank_mask:0xf
    v_add_f32 v96, v96, v97
    v_add_f32 v98, v98, v99
    v_cvt_pk_bf16_f32 v49, v96, v98
    v_lshlrev_b32 v96, 16, v49
    v_and_b32 v97, s97, v49
    v_max3_f32 v93, v96, v97, v93
    s_waitcnt vmcnt(4)
    v_mfma_f32_16x16x32_bf16 v[56:59], v[240:243], v[24:27], 0
    buffer_load_dwordx4 v[104:107], v4, s[48:51], s55 offen offset:1792 nt
    s_waitcnt vmcnt(4)
    v_mfma_f32_16x16x32_bf16 v[56:59], v[244:247], v[28:31], v[56:59]
    s_add_u32 s55, s52, 0
    buffer_load_dwordx4 v[108:111], v5, s[44:47], s55 offen offset:0 nt
    s_waitcnt vmcnt(4)
    v_mfma_f32_16x16x32_bf16 v[60:63], v[248:251], v[24:27], 0
    buffer_load_dwordx4 v[112:115], v5, s[44:47], s55 offen offset:256 nt
    s_waitcnt vmcnt(4)
    v_mfma_f32_16x16x32_bf16 v[60:63], v[252:255], v[28:31], v[60:63]
    buffer_load_dwordx4 v[116:119], v5, s[44:47], s55 offen offset:512 nt
    v_mov_b32_dpp v96, v52 quad_perm:[0,0,0,0] row_mask:0xf bank_mask:0xf
    v_mov_b32_dpp v97, v54 quad_perm:[2,2,2,2] row_mask:0xf bank_mask:0xf
    v_mov_b32_dpp v98, v56 quad_perm:[0,0,0,0] row_mask:0xf bank_mask:0xf
    v_mov_b32_dpp v99, v58 quad_perm:[2,2,2,2] row_mask:0xf bank_mask:0xf
    v_add_f32_dpp v96, v53, v96 quad_perm:[1,1,1,1] row_mask:0xf bank_mask:0xf
    v_add_f32_dpp v97, v55, v97 quad_perm:[3,3,3,3] row_mask:0xf bank_mask:0xf
    v_add_f32_dpp v98, v57, v98 quad_perm:[1,1,1,1] row_mask:0xf bank_mask:0xf
    v_add_f32_dpp v99, v59, v99 quad_perm:[3,3,3,3] row_mask:0xf bank_mask:0xf
    v_add_f32 v96, v96, v97
    v_add_f32 v98, v98, v99
    v_cvt_pk_bf16_f32 v50, v96, v98
    v_lshlrev_b32 v96, 16, v50
    v_and_b32 v97, s97, v50
    v_max3_f32 v93, v96, v97, v93
    s_waitcnt vmcnt(4)
    v_mfma_f32_16x16x32_bf16 v[64:67], v[100:103], v[24:27], 0
    buffer_load_dwordx4 v[120:123], v5, s[44:47], s55 offen offset:768 nt
    s_waitcnt vmcnt(4)
    v_mfma_f32_16x16x32_bf16 v[64:67], v[104:107], v[28:31], v[64:67]
    buffer_load_dwordx4 v[124:127], v5, s[44:47], s55 offen offset:1024 nt
    v_mov_b32 v96, v92
    s_nop 1
    v_permlane16_swap_b32 v92, v96
    s_nop 0
    v_max_f32 v92, v92, v96
    v_mov_b32 v96, v92
    s_nop 1
    v_permlane32_swap_b32 v92, v96
    s_nop 0
    v_max_f32 v92, v92, v96
    v_mul_f32 v92, s96, v92
    v_lshlrev_b32 v96, 16, v32
    v_fma_f32 v96, v96, s96, -v92
    v_exp_f32 v96, v96
    s_nop 0
    v_cvt_pk_bf16_f32 v97, v96, v96
    v_and_b32 v68, v10, v97
    v_and_b32 v69, v11, v97
    v_and_b32 v70, v12, v97
    v_and_b32 v71, v13, v97
    v_add_f32 v94, v94, v96
    s_waitcnt vmcnt(4)
    v_mfma_f32_16x16x32_bf16 v[76:79], v[68:71], v[108:111], 0
    buffer_load_dwordx4 v[128:131], v5, s[44:47], s55 offen offset:1280 nt
    s_waitcnt vmcnt(4)
    v_mfma_f32_16x16x32_bf16 v[80:83], v[68:71], v[112:115], 0
    buffer_load_dwordx4 v[132:135], v5, s[44:47], s55 offen offset:1536 nt
    v_mov_b32_dpp v96, v60 quad_perm:[0,0,0,0] row_mask:0xf bank_mask:0xf
    v_mov_b32_dpp v97, v62 quad_perm:[2,2,2,2] row_mask:0xf bank_mask:0xf
    v_mov_b32_dpp v98, v64 quad_perm:[0,0,0,0] row_mask:0xf bank_mask:0xf
    v_mov_b32_dpp v99, v66 quad_perm:[2,2,2,2] row_mask:0xf bank_mask:0xf
    v_add_f32_dpp v96, v61, v96 quad_perm:[1,1,1,1] row_mask:0xf bank_mask:0xf
    v_add_f32_dpp v97, v63, v97 quad_perm:[3,3,3,3] row_mask:0xf bank_mask:0xf
    v_add_f32_dpp v98, v65, v98 quad_perm:[1,1,1,1] row_mask:0xf bank_mask:0xf
    v_add_f32_dpp v99, v67, v99 quad_perm:[3,3,3,3] row_mask:0xf bank_mask:0xf
    v_add_f32 v96, v96, v97
    v_add_f32 v98, v98, v99
    v_cvt_pk_bf16_f32 v51, v96, v98
    v_lshlrev_b32 v96, 16, v51
    v_and_b32 v97, s97, v51
    v_max3_f32 v93, v96, v97, v93
    v_and_b32 v96, s97, v32
    v_fma_f32 v96, v96, s96, -v92
    v_exp_f32 v96, v96
    s_nop 0
    v_cvt_pk_bf16_f32 v97, v96, v96
    v_and_b32 v72, v10, v97
    v_and_b32 v73, v11, v97
    v_and_b32 v74, v12, v97
    v_and_b32 v75, v13, v97
    v_add_f32 v94, v94, v96
    s_waitcnt vmcnt(4)
    v_mfma_f32_16x16x32_bf16 v[76:79], v[72:75], v[116:119], v[76:79]
    buffer_load_dwordx4 v[136:139], v5, s[44:47], s55 offen offset:1792 nt
    s_waitcnt vmcnt(4)
    v_mfma_f32_16x16x32_bf16 v[80:83], v[72:75], v[120:123], v[80:83]
    s_add_u32 s55, s52, 32768
    buffer_load_dwordx4 v[140:143], v5, s[44:47], s55 offen offset:0 nt
    v_lshlrev_b32 v96, 16, v33
    v_fma_f32 v96, v96, s96, -v92
    v_exp_f32 v96, v96
    s_nop 0
    v_cvt_pk_bf16_f32 v97, v96, v96
    v_and_b32 v68, v10, v97
    v_and_b32 v69, v11, v97
    v_and_b32 v70, v12, v97
    v_and_b32 v71, v13, v97
    v_add_f32 v94, v94, v96
    v_lshrrev_b32 v8, 5, v0
    v_lshlrev_b32 v59, 10, v8
    v_lshl_add_u32 v59, v2, 5, v59
    v_and_b32 v9, 1, v3
    v_lshl_add_u32 v59, v9, 4, v59
    s_lshl_b32 s54, s3, 12
    v_add_u32 v59, s54, v59
    v_mul_u32_u24 v67, 14, v8
    v_lshrrev_b32 v60, 2, v14
    v_add_u32 v67, v67, v60
    v_lshlrev_b32 v67, 14, v67
    v_lshl_add_u32 v67, v9, 4, v67
    v_and_b32 v9, 3, v14
    v_lshl_add_u32 v67, v9, 5, v67
    v_cmp_gt_u32 vcc, 56, v14
    v_mov_b32 v9, 0x40000000
    s_lshr_b32 s11, s34, 4
    s_mul_i32 s11, s11, 458752
    v_cndmask_b32 v67, v9, v67, vcc
    s_and_b32 s54, s34, 15
    s_lshl_b32 s5, s31, 4
    s_add_u32 s54, s54, s5
    s_lshl_b32 s54, s54, 7
    s_add_u32 s11, s11, s54
    s_add_u32 s11, s11, 0x200000
    s_lshl_b32 s54, s3, 5
    v_lshlrev_b32 v65, 7, v8
    v_and_b32 v9, 1, v0
    v_lshl_add_u32 v65, v9, 4, v65
    v_add_u32 v65, s54, v65
    v_mov_b32 v62, s54
    v_lshrrev_b32 v8, 1, v0
    v_lshlrev_b32 v64, 7, v8
    v_lshl_add_u32 v64, v9, 4, v64
    s_lshl_b32 s10, s31, 5
    s_add_u32 s10, s10, s34
    s_lshl_b32 s10, s10, 12
    s_add_u32 s10, s10, 0x80000
    s_add_u32 s10, s10, s54
    v_bfe_u32 v8, v0, 3, 1
    v_lshlrev_b32 v66, 7, v8
    v_lshl_add_u32 v66, v3, 5, v66
    v_lshlrev_b32 v60, 5, v8
    s_lshl_b32 s54, s3, 3
    v_add_u32 v60, s54, v60
    v_lshlrev_b32 v61, 4, v0
    s_lshl_b32 s54, s3, 10
    v_add_u32 v61, s54, v61
    v_lshrrev_b32 v8, 3, v0
    v_lshlrev_b32 v63, 12, v8
    v_and_b32 v9, 7, v0
    v_lshl_add_u32 v63, v9, 4, v63
    s_lshl_b32 s54, s31, 2
    s_add_u32 s54, s54, s3
    s_lshl_b32 s5, s54, 15
    s_lshl_b32 s54, s34, 7
    s_add_u32 s5, s5, s54
    s_add_u32 s5, s5, 0x80000
    s_waitcnt vmcnt(4)
    v_mfma_f32_16x16x32_bf16 v[76:79], v[68:71], v[124:127], v[76:79]
    buffer_load_dwordx4 v[144:147], v5, s[44:47], s55 offen offset:256 nt
    s_waitcnt vmcnt(4)
    v_mfma_f32_16x16x32_bf16 v[80:83], v[68:71], v[128:131], v[80:83]
    buffer_load_dwordx4 v[148:151], v5, s[44:47], s55 offen offset:512 nt
    v_and_b32 v96, s97, v33
    v_fma_f32 v96, v96, s96, -v92
    v_exp_f32 v96, v96
    s_nop 0
    v_cvt_pk_bf16_f32 v97, v96, v96
    v_and_b32 v72, v10, v97
    v_and_b32 v73, v11, v97
    v_and_b32 v74, v12, v97
    v_and_b32 v75, v13, v97
    v_add_f32 v94, v94, v96
    s_waitcnt vmcnt(4)
    v_mfma_f32_16x16x32_bf16 v[76:79], v[72:75], v[132:135], v[76:79]
    buffer_load_dwordx4 v[152:155], v5, s[44:47], s55 offen offset:768 nt
    s_waitcnt vmcnt(4)
    v_mfma_f32_16x16x32_bf16 v[80:83], v[72:75], v[136:139], v[80:83]
    buffer_load_dwordx4 v[156:159], v5, s[44:47], s55 offen offset:1024 nt
    v_lshlrev_b32 v96, 16, v34
    v_fma_f32 v96, v96, s96, -v92
    v_exp_f32 v96, v96
    s_nop 0
    v_cvt_pk_bf16_f32 v97, v96, v96
    v_and_b32 v68, v10, v97
    v_and_b32 v69, v11, v97
    v_and_b32 v70, v12, v97
    v_and_b32 v71, v13, v97
    v_add_f32 v94, v94, v96
    s_waitcnt vmcnt(4)
    v_mfma_f32_16x16x32_bf16 v[76:79], v[68:71], v[140:143], v[76:79]
    buffer_load_dwordx4 v[160:163], v5, s[44:47], s55 offen offset:1280 nt
    s_waitcnt vmcnt(4)
    v_mfma_f32_16x16x32_bf16 v[80:83], v[68:71], v[144:147], v[80:83]
    buffer_load_dwordx4 v[164:167], v5, s[44:47], s55 offen offset:1536 nt
    v_and_b32 v96, s97, v34
    v_fma_f32 v96, v96, s96, -v92
    v_exp_f32 v96, v96
    s_nop 0
    v_cvt_pk_bf16_f32 v97, v96, v96
    v_and_b32 v72, v10, v97
    v_and_b32 v73, v11, v97
    v_and_b32 v74, v12, v97
    v_and_b32 v75, v13, v97
    v_add_f32 v94, v94, v96
    s_waitcnt vmcnt(4)
    v_mfma_f32_16x16x32_bf16 v[76:79], v[72:75], v[148:151], v[76:79]
    buffer_load_dwordx4 v[168:171], v5, s[44:47], s55 offen offset:1792 nt
    s_waitcnt vmcnt(4)
    v_mfma_f32_16x16x32_bf16 v[80:83], v[72:75], v[152:155], v[80:83]
    s_add_u32 s55, s52, 65536
    buffer_load_dwordx4 v[172:175], v5, s[44:47], s55 offen offset:0 nt
    v_lshlrev_b32 v96, 16, v35
    v_fma_f32 v96, v96, s96, -v92
    v_exp_f32 v96, v96
    s_nop 0
    v_cvt_pk_bf16_f32 v97, v96, v96
    v_and_b32 v68, v10, v97
    v_and_b32 v69, v11, v97
    v_and_b32 v70, v12, v97
    v_and_b32 v71, v13, v97
    v_add_f32 v94, v94, v96
    s_waitcnt vmcnt(4)
    v_mfma_f32_16x16x32_bf16 v[76:79], v[68:71], v[156:159], v[76:79]
    buffer_load_dwordx4 v[176:179], v5, s[44:47], s55 offen offset:256 nt
    s_waitcnt vmcnt(4)
    v_mfma_f32_16x16x32_bf16 v[80:83], v[68:71], v[160:163], v[80:83]
    buffer_load_dwordx4 v[180:183], v5, s[44:47], s55 offen offset:512 nt
    v_and_b32 v96, s97, v35
    v_fma_f32 v96, v96, s96, -v92
    v_exp_f32 v96, v96
    s_nop 0
    v_cvt_pk_bf16_f32 v97, v96, v96
    v_and_b32 v72, v10, v97
    v_and_b32 v73, v11, v97
    v_and_b32 v74, v12, v97
    v_and_b32 v75, v13, v97
    v_add_f32 v94, v94, v96
    s_waitcnt vmcnt(4)
    v_mfma_f32_16x16x32_bf16 v[76:79], v[72:75], v[164:167], v[76:79]
    buffer_load_dwordx4 v[184:187], v5, s[44:47], s55 offen offset:768 nt
    s_waitcnt vmcnt(4)
    v_mfma_f32_16x16x32_bf16 v[80:83], v[72:75], v[168:171], v[80:83]
    buffer_load_dwordx4 v[188:191], v5, s[44:47], s55 offen offset:1024 nt
    v_lshlrev_b32 v96, 16, v36
    v_fma_f32 v96, v96, s96, -v92
    v_exp_f32 v96, v96
    s_nop 0
    v_cvt_pk_bf16_f32 v97, v96, v96
    v_and_b32 v68, v10, v97
    v_and_b32 v69, v11, v97
    v_and_b32 v70, v12, v97
    v_and_b32 v71, v13, v97
    v_add_f32 v94, v94, v96
    s_waitcnt vmcnt(4)
    v_mfma_f32_16x16x32_bf16 v[76:79], v[68:71], v[172:175], v[76:79]
    buffer_load_dwordx4 v[192:195], v5, s[44:47], s55 offen offset:1280 nt
    s_waitcnt vmcnt(4)
    v_mfma_f32_16x16x32_bf16 v[80:83], v[68:71], v[176:179], v[80:83]
    buffer_load_dwordx4 v[196:199], v5, s[44:47], s55 offen offset:1536 nt
    v_and_b32 v96, s97, v36
    v_fma_f32 v96, v96, s96, -v92
    v_exp_f32 v96, v96
    s_nop 0
    v_cvt_pk_bf16_f32 v97, v96, v96
    v_and_b32 v72, v10, v97
    v_and_b32 v73, v11, v97
    v_and_b32 v74, v12, v97
    v_and_b32 v75, v13, v97
    v_add_f32 v94, v94, v96
    s_waitcnt vmcnt(4)
    v_mfma_f32_16x16x32_bf16 v[76:79], v[72:75], v[180:183], v[76:79]
    buffer_load_dwordx4 v[200:203], v5, s[44:47], s55 offen offset:1792 nt
    s_waitcnt vmcnt(4)
    v_mfma_f32_16x16x32_bf16 v[80:83], v[72:75], v[184:187], v[80:83]
    s_add_u32 s55, s52, 98304
    buffer_load_dwordx4 v[204:207], v5, s[44:47], s55 offen offset:0 nt
    v_lshlrev_b32 v96, 16, v37
    v_fma_f32 v96, v96, s96, -v92
    v_exp_f32 v96, v96
    s_nop 0
    v_cvt_pk_bf16_f32 v97, v96, v96
    v_and_b32 v68, v10, v97
    v_and_b32 v69, v11, v97
    v_and_b32 v70, v12, v97
    v_and_b32 v71, v13, v97
    v_add_f32 v94, v94, v96
    s_waitcnt vmcnt(4)
    v_mfma_f32_16x16x32_bf16 v[76:79], v[68:71], v[188:191], v[76:79]
    buffer_load_dwordx4 v[208:211], v5, s[44:47], s55 offen offset:256 nt
    s_waitcnt vmcnt(4)
    v_mfma_f32_16x16x32_bf16 v[80:83], v[68:71], v[192:195], v[80:83]
    buffer_load_dwordx4 v[212:215], v5, s[44:47], s55 offen offset:512 nt
    v_and_b32 v96, s97, v37
    v_fma_f32 v96, v96, s96, -v92
    v_exp_f32 v96, v96
    s_nop 0
    v_cvt_pk_bf16_f32 v97, v96, v96
    v_and_b32 v72, v10, v97
    v_and_b32 v73, v11, v97
    v_and_b32 v74, v12, v97
    v_and_b32 v75, v13, v97
    v_add_f32 v94, v94, v96
    s_waitcnt vmcnt(4)
    v_mfma_f32_16x16x32_bf16 v[76:79], v[72:75], v[196:199], v[76:79]
    buffer_load_dwordx4 v[216:219], v5, s[44:47], s55 offen offset:768 nt
    s_waitcnt vmcnt(4)
    v_mfma_f32_16x16x32_bf16 v[80:83], v[72:75], v[200:203], v[80:83]
    buffer_load_dwordx4 v[220:223], v5, s[44:47], s55 offen offset:1024 nt
    v_lshlrev_b32 v96, 16, v38
    v_fma_f32 v96, v96, s96, -v92
    v_exp_f32 v96, v96
    s_nop 0
    v_cvt_pk_bf16_f32 v97, v96, v96
    v_and_b32 v68, v10, v97
    v_and_b32 v69, v11, v97
    v_and_b32 v70, v12, v97
    v_and_b32 v71, v13, v97
    v_add_f32 v94, v94, v96
    s_waitcnt vmcnt(4)
    v_mfma_f32_16x16x32_bf16 v[76:79], v[68:71], v[204:207], v[76:79]
    buffer_load_dwordx4 v[224:227], v5, s[44:47], s55 offen offset:1280 nt
    s_waitcnt vmcnt(4)
    v_mfma_f32_16x16x32_bf16 v[80:83], v[68:71], v[208:211], v[80:83]
    buffer_load_dwordx4 v[228:231], v5, s[44:47], s55 offen offset:1536 nt
    v_and_b32 v96, s97, v38
    v_fma_f32 v96, v96, s96, -v92
    v_exp_f32 v96, v96
    s_nop 0
    v_cvt_pk_bf16_f32 v97, v96, v96
    v_and_b32 v72, v10, v97
    v_and_b32 v73, v11, v97
    v_and_b32 v74, v12, v97
    v_and_b32 v75, v13, v97
    v_add_f32 v94, v94, v96
    s_waitcnt vmcnt(4)
    v_mfma_f32_16x16x32_bf16 v[76:79], v[72:75], v[212:215], v[76:79]
    buffer_load_dwordx4 v[232:235], v5, s[44:47], s55 offen offset:1792 nt
    s_waitcnt vmcnt(4)
    v_mfma_f32_16x16x32_bf16 v[80:83], v[72:75], v[216:219], v[80:83]
    s_add_u32 s55, s52, 131072
    buffer_load_dwordx4 v[236:239], v5, s[44:47], s55 offen offset:0 nt
    v_lshlrev_b32 v96, 16, v39
    v_fma_f32 v96, v96, s96, -v92
    v_exp_f32 v96, v96
    s_nop 0
    v_cvt_pk_bf16_f32 v97, v96, v96
    v_and_b32 v68, v10, v97
    v_and_b32 v69, v11, v97
    v_and_b32 v70, v12, v97
    v_and_b32 v71, v13, v97
    v_add_f32 v94, v94, v96
    s_waitcnt vmcnt(4)
    v_mfma_f32_16x16x32_bf16 v[76:79], v[68:71], v[220:223], v[76:79]
    buffer_load_dwordx4 v[240:243], v5, s[44:47], s55 offen offset:256 nt
    s_waitcnt vmcnt(4)
    v_mfma_f32_16x16x32_bf16 v[80:83], v[68:71], v[224:227], v[80:83]
    buffer_load_dwordx4 v[244:247], v5, s[44:47], s55 offen offset:512 nt
    v_and_b32 v96, s97, v39
    v_fma_f32 v96, v96, s96, -v92
    v_exp_f32 v96, v96
    s_nop 0
    v_cvt_pk_bf16_f32 v97, v96, v96
    v_and_b32 v72, v10, v97
    v_and_b32 v73, v11, v97
    v_and_b32 v74, v12, v97
    v_and_b32 v75, v13, v97
    v_add_f32 v94, v94, v96
    s_waitcnt vmcnt(4)
    v_mfma_f32_16x16x32_bf16 v[76:79], v[72:75], v[228:231], v[76:79]
    buffer_load_dwordx4 v[248:251], v5, s[44:47], s55 offen offset:768 nt
    s_waitcnt vmcnt(4)
    v_mfma_f32_16x16x32_bf16 v[80:83], v[72:75], v[232:235], v[80:83]
    buffer_load_dwordx4 v[252:255], v5, s[44:47], s55 offen offset:1024 nt
    v_lshlrev_b32 v96, 16, v40
    v_fma_f32 v96, v96, s96, -v92
    v_exp_f32 v96, v96
    s_nop 0
    v_cvt_pk_bf16_f32 v97, v96, v96
    v_and_b32 v68, v10, v97
    v_and_b32 v69, v11, v97
    v_and_b32 v70, v12, v97
    v_and_b32 v71, v13, v97
    v_add_f32 v94, v94, v96
    s_waitcnt vmcnt(4)
    v_mfma_f32_16x16x32_bf16 v[76:79], v[68:71], v[236:239], v[76:79]
    buffer_load_dwordx4 v[100:103], v5, s[44:47], s55 offen offset:1280 nt
    s_waitcnt vmcnt(4)
    v_mfma_f32_16x16x32_bf16 v[80:83], v[68:71], v[240:243], v[80:83]
    buffer_load_dwordx4 v[104:107], v5, s[44:47], s55 offen offset:1536 nt
    v_and_b32 v96, s97, v40
    v_fma_f32 v96, v96, s96, -v92
    v_exp_f32 v96, v96
    s_nop 0
    v_cvt_pk_bf16_f32 v97, v96, v96
    v_and_b32 v72, v10, v97
    v_and_b32 v73, v11, v97
    v_and_b32 v74, v12, v97
    v_and_b32 v75, v13, v97
    v_add_f32 v94, v94, v96
    s_waitcnt vmcnt(4)
    v_mfma_f32_16x16x32_bf16 v[76:79], v[72:75], v[244:247], v[76:79]
    buffer_load_dwordx4 v[108:111], v5, s[44:47], s55 offen offset:1792 nt
    s_waitcnt vmcnt(4)
    v_mfma_f32_16x16x32_bf16 v[80:83], v[72:75], v[248:251], v[80:83]
    s_add_u32 s55, s52, 163840
    buffer_load_dwordx4 v[112:115], v5, s[44:47], s55 offen offset:0 nt
    v_lshlrev_b32 v96, 16, v41
    v_fma_f32 v96, v96, s96, -v92
    v_exp_f32 v96, v96
    s_nop 0
    v_cvt_pk_bf16_f32 v97, v96, v96
    v_and_b32 v68, v10, v97
    v_and_b32 v69, v11, v97
    v_and_b32 v70, v12, v97
    v_and_b32 v71, v13, v97
    v_add_f32 v94, v94, v96
    s_waitcnt vmcnt(4)
    v_mfma_f32_16x16x32_bf16 v[76:79], v[68:71], v[252:255], v[76:79]
    buffer_load_dwordx4 v[116:119], v5, s[44:47], s55 offen offset:256 nt
    s_waitcnt vmcnt(4)
    v_mfma_f32_16x16x32_bf16 v[80:83], v[68:71], v[100:103], v[80:83]
    buffer_load_dwordx4 v[120:123], v5, s[44:47], s55 offen offset:512 nt
    v_and_b32 v96, s97, v41
    v_fma_f32 v96, v96, s96, -v92
    v_exp_f32 v96, v96
    s_nop 0
    v_cvt_pk_bf16_f32 v97, v96, v96
    v_and_b32 v72, v10, v97
    v_and_b32 v73, v11, v97
    v_and_b32 v74, v12, v97
    v_and_b32 v75, v13, v97
    v_add_f32 v94, v94, v96
    s_waitcnt vmcnt(4)
    v_mfma_f32_16x16x32_bf16 v[76:79], v[72:75], v[104:107], v[76:79]
    buffer_load_dwordx4 v[124:127], v5, s[44:47], s55 offen offset:768 nt
    s_waitcnt vmcnt(4)
    v_mfma_f32_16x16x32_bf16 v[80:83], v[72:75], v[108:111], v[80:83]
    buffer_load_dwordx4 v[128:131], v5, s[44:47], s55 offen offset:1024 nt
    v_lshlrev_b32 v96, 16, v42
    v_fma_f32 v96, v96, s96, -v92
    v_exp_f32 v96, v96
    s_nop 0
    v_cvt_pk_bf16_f32 v97, v96, v96
    v_and_b32 v68, v10, v97
    v_and_b32 v69, v11, v97
    v_and_b32 v70, v12, v97
    v_and_b32 v71, v13, v97
    v_add_f32 v94, v94, v96
    s_waitcnt vmcnt(4)
    v_mfma_f32_16x16x32_bf16 v[76:79], v[68:71], v[112:115], v[76:79]
    buffer_load_dwordx4 v[132:135], v5, s[44:47], s55 offen offset:1280 nt
    s_waitcnt vmcnt(4)
    v_mfma_f32_16x16x32_bf16 v[80:83], v[68:71], v[116:119], v[80:83]
    buffer_load_dwordx4 v[136:139], v5, s[44:47], s55 offen offset:1536 nt
    v_and_b32 v96, s97, v42
    v_fma_f32 v96, v96, s96, -v92
    v_exp_f32 v96, v96
    s_nop 0
    v_cvt_pk_bf16_f32 v97, v96, v96
    v_and_b32 v72, v10, v97
    v_and_b32 v73, v11, v97
    v_and_b32 v74, v12, v97
    v_and_b32 v75, v13, v97
    v_add_f32 v94, v94, v96
    s_waitcnt vmcnt(4)
    v_mfma_f32_16x16x32_bf16 v[76:79], v[72:75], v[120:123], v[76:79]
    buffer_load_dwordx4 v[140:143], v5, s[44:47], s55 offen offset:1792 nt
    s_waitcnt vmcnt(4)
    v_mfma_f32_16x16x32_bf16 v[80:83], v[72:75], v[124:127], v[80:83]
    s_add_u32 s55, s52, 196608
    buffer_load_dwordx4 v[144:147], v5, s[44:47], s55 offen offset:0 nt
    v_lshlrev_b32 v96, 16, v43
    v_fma_f32 v96, v96, s96, -v92
    v_exp_f32 v96, v96
    s_nop 0
    v_cvt_pk_bf16_f32 v97, v96, v96
    v_and_b32 v68, v10, v97
    v_and_b32 v69, v11, v97
    v_and_b32 v70, v12, v97
    v_and_b32 v71, v13, v97
    v_add_f32 v94, v94, v96
    s_waitcnt vmcnt(4)
    v_mfma_f32_16x16x32_bf16 v[76:79], v[68:71], v[128:131], v[76:79]
    buffer_load_dwordx4 v[148:151], v5, s[44:47], s55 offen offset:256 nt
    s_waitcnt vmcnt(4)
    v_mfma_f32_16x16x32_bf16 v[80:83], v[68:71], v[132:135], v[80:83]
    buffer_load_dwordx4 v[152:155], v5, s[44:47], s55 offen offset:512 nt
    v_and_b32 v96, s97, v43
    v_fma_f32 v96, v96, s96, -v92
    v_exp_f32 v96, v96
    s_nop 0
    v_cvt_pk_bf16_f32 v97, v96, v96
    v_and_b32 v72, v10, v97
    v_and_b32 v73, v11, v97
    v_and_b32 v74, v12, v97
    v_and_b32 v75, v13, v97
    v_add_f32 v94, v94, v96
    s_waitcnt vmcnt(4)
    v_mfma_f32_16x16x32_bf16 v[76:79], v[72:75], v[136:139], v[76:79]
    buffer_load_dwordx4 v[156:159], v5, s[44:47], s55 offen offset:768 nt
    s_waitcnt vmcnt(4)
    v_mfma_f32_16x16x32_bf16 v[80:83], v[72:75], v[140:143], v[80:83]
    buffer_load_dwordx4 v[160:163], v5, s[44:47], s55 offen offset:1024 nt
    v_lshlrev_b32 v96, 16, v44
    v_fma_f32 v96, v96, s96, -v92
    v_exp_f32 v96, v96
    s_nop 0
    v_cvt_pk_bf16_f32 v97, v96, v96
    v_and_b32 v68, v10, v97
    v_and_b32 v69, v11, v97
    v_and_b32 v70, v12, v97
    v_and_b32 v71, v13, v97
    v_add_f32 v94, v94, v96
    s_waitcnt vmcnt(4)
    v_mfma_f32_16x16x32_bf16 v[76:79], v[68:71], v[144:147], v[76:79]
    buffer_load_dwordx4 v[164:167], v5, s[44:47], s55 offen offset:1280 nt
    s_waitcnt vmcnt(4)
    v_mfma_f32_16x16x32_bf16 v[80:83], v[68:71], v[148:151], v[80:83]
    buffer_load_dwordx4 v[168:171], v5, s[44:47], s55 offen offset:1536 nt
    v_and_b32 v96, s97, v44
    v_fma_f32 v96, v96, s96, -v92
    v_exp_f32 v96, v96
    s_nop 0
    v_cvt_pk_bf16_f32 v97, v96, v96
    v_and_b32 v72, v10, v97
    v_and_b32 v73, v11, v97
    v_and_b32 v74, v12, v97
    v_and_b32 v75, v13, v97
    v_add_f32 v94, v94, v96
    s_waitcnt vmcnt(4)
    v_mfma_f32_16x16x32_bf16 v[76:79], v[72:75], v[152:155], v[76:79]
    buffer_load_dwordx4 v[172:175], v5, s[44:47], s55 offen offset:1792 nt
    s_waitcnt vmcnt(4)
    v_mfma_f32_16x16x32_bf16 v[80:83], v[72:75], v[156:159], v[80:83]
    s_add_u32 s55, s52, 229376
    buffer_load_dwordx4 v[176:179], v5, s[44:47], s55 offen offset:0 nt
    v_lshlrev_b32 v96, 16, v45
    v_fma_f32 v96, v96, s96, -v92
    v_exp_f32 v96, v96
    s_nop 0
    v_cvt_pk_bf16_f32 v97, v96, v96
    v_and_b32 v68, v10, v97
    v_and_b32 v69, v11, v97
    v_and_b32 v70, v12, v97
    v_and_b32 v71, v13, v97
    v_add_f32 v94, v94, v96
    s_waitcnt vmcnt(4)
    v_mfma_f32_16x16x32_bf16 v[76:79], v[68:71], v[160:163], v[76:79]
    buffer_load_dwordx4 v[180:183], v5, s[44:47], s55 offen offset:256 nt
    s_waitcnt vmcnt(4)
    v_mfma_f32_16x16x32_bf16 v[80:83], v[68:71], v[164:167], v[80:83]
    buffer_load_dwordx4 v[184:187], v5, s[44:47], s55 offen offset:512 nt
    v_and_b32 v96, s97, v45
    v_fma_f32 v96, v96, s96, -v92
    v_exp_f32 v96, v96
    s_nop 0
    v_cvt_pk_bf16_f32 v97, v96, v96
    v_and_b32 v72, v10, v97
    v_and_b32 v73, v11, v97
    v_and_b32 v74, v12, v97
    v_and_b32 v75, v13, v97
    v_add_f32 v94, v94, v96
    s_waitcnt vmcnt(4)
    v_mfma_f32_16x16x32_bf16 v[76:79], v[72:75], v[168:171], v[76:79]
    buffer_load_dwordx4 v[188:191], v5, s[44:47], s55 offen offset:768 nt
    s_waitcnt vmcnt(4)
    v_mfma_f32_16x16x32_bf16 v[80:83], v[72:75], v[172:175], v[80:83]
    buffer_load_dwordx4 v[192:195], v5, s[44:47], s55 offen offset:1024 nt
    v_lshlrev_b32 v96, 16, v46
    v_fma_f32 v96, v96, s96, -v92
    v_exp_f32 v96, v96
    s_nop 0
    v_cvt_pk_bf16_f32 v97, v96, v96
    v_and_b32 v68, v10, v97
    v_and_b32 v69, v11, v97
    v_and_b32 v70, v12, v97
    v_and_b32 v71, v13, v97
    v_add_f32 v94, v94, v96
    s_waitcnt vmcnt(4)
    v_mfma_f32_16x16x32_bf16 v[76:79], v[68:71], v[176:179], v[76:79]
    buffer_load_dwordx4 v[196:199], v5, s[44:47], s55 offen offset:1280 nt
    s_waitcnt vmcnt(4)
    v_mfma_f32_16x16x32_bf16 v[80:83], v[68:71], v[180:183], v[80:83]
    buffer_load_dwordx4 v[200:203], v5, s[44:47], s55 offen offset:1536 nt
    v_and_b32 v96, s97, v46
    v_fma_f32 v96, v96, s96, -v92
    v_exp_f32 v96, v96
    s_nop 0
    v_cvt_pk_bf16_f32 v97, v96, v96
    v_and_b32 v72, v10, v97
    v_and_b32 v73, v11, v97
    v_and_b32 v74, v12, v97
    v_and_b32 v75, v13, v97
    v_add_f32 v94, v94, v96
    s_waitcnt vmcnt(4)
    v_mfma_f32_16x16x32_bf16 v[76:79], v[72:75], v[184:187], v[76:79]
    buffer_load_dwordx4 v[204:207], v5, s[44:47], s55 offen offset:1792 nt
    s_waitcnt vmcnt(4)
    v_mfma_f32_16x16x32_bf16 v[80:83], v[72:75], v[188:191], v[80:83]
    s_add_u32 s55, s53, 0
    buffer_load_dwordx4 v[208:211], v5, s[88:91], s55 offen offset:0 nt
    v_lshlrev_b32 v96, 16, v47
    v_fma_f32 v96, v96, s96, -v92
    v_exp_f32 v96, v96
    s_nop 0
    v_cvt_pk_bf16_f32 v97, v96, v96
    v_and_b32 v68, v10, v97
    v_and_b32 v69, v11, v97
    v_and_b32 v70, v12, v97
    v_and_b32 v71, v13, v97
    v_add_f32 v94, v94, v96
    s_waitcnt vmcnt(4)
    v_mfma_f32_16x16x32_bf16 v[76:79], v[68:71], v[192:195], v[76:79]
    buffer_load_dwordx4 v[212:215], v5, s[88:91], s55 offen offset:256 nt
    s_waitcnt vmcnt(4)
    v_mfma_f32_16x16x32_bf16 v[80:83], v[68:71], v[196:199], v[80:83]
    buffer_load_dwordx4 v[216:219], v5, s[88:91], s55 offen offset:512 nt
    v_and_b32 v96, s97, v47
    v_fma_f32 v96, v96, s96, -v92
    v_exp_f32 v96, v96
    s_nop 0
    v_cvt_pk_bf16_f32 v97, v96, v96
    v_and_b32 v72, v10, v97
    v_and_b32 v73, v11, v97
    v_and_b32 v74, v12, v97
    v_and_b32 v75, v13, v97
    v_add_f32 v94, v94, v96
    s_waitcnt vmcnt(4)
    v_mfma_f32_16x16x32_bf16 v[76:79], v[72:75], v[200:203], v[76:79]
    buffer_load_dwordx4 v[220:223], v5, s[88:91], s55 offen offset:768 nt
    s_waitcnt vmcnt(4)
    v_mfma_f32_16x16x32_bf16 v[80:83], v[72:75], v[204:207], v[80:83]
    buffer_load_dwordx4 v[224:227], v5, s[88:91], s55 offen offset:1024 nt
    v_mov_b32 v96, v93
    s_nop 1
    v_permlane16_swap_b32 v93, v96
    s_nop 0
    v_max_f32 v93, v93, v96
    v_mov_b32 v96, v93
    s_nop 1
    v_permlane32_swap_b32 v93, v96
    s_nop 0
    v_max_f32 v93, v93, v96
    v_mul_f32 v93, s96, v93
    v_lshlrev_b32 v96, 16, v48
    v_fma_f32 v96, v96, s96, -v93
    v_exp_f32 v96, v96
    s_nop 0
    v_cvt_pk_bf16_f32 v97, v96, v96
    v_and_b32 v68, v10, v97
    v_and_b32 v69, v11, v97
    v_and_b32 v70, v12, v97
    v_and_b32 v71, v13, v97
    v_add_f32 v95, v95, v96
    s_waitcnt vmcnt(4)
    v_mfma_f32_16x16x32_bf16 v[84:87], v[68:71], v[208:211], 0
    buffer_load_dwordx4 v[228:231], v5, s[88:91], s55 offen offset:1280 nt
    s_waitcnt vmcnt(4)
    v_mfma_f32_16x16x32_bf16 v[88:91], v[68:71], v[212:215], 0
    buffer_load_dwordx4 v[232:235], v5, s[88:91], s55 offen offset:1536 nt
    v_mov_b32 v96, v94
    s_nop 1
    v_permlane16_swap_b32 v94, v96
    s_nop 0
    v_add_f32 v94, v94, v96
    v_mov_b32 v96, v94
    s_nop 1
    v_permlane32_swap_b32 v94, v96
    s_nop 0
    v_add_f32 v94, v94, v96
    v_mov_b32 v98, v92
    v_mov_b32 v99, v94
    ds_write_b64 v60, v[98:99] offset:18432
    ds_write_b128 v59, v[76:79] offset:2048
    ds_write_b128 v59, v[80:83] offset:2560
    v_and_b32 v96, s97, v48
    v_fma_f32 v96, v96, s96, -v93
    v_exp_f32 v96, v96
    s_nop 0
    v_cvt_pk_bf16_f32 v97, v96, v96
    v_and_b32 v72, v10, v97
    v_and_b32 v73, v11, v97
    v_and_b32 v74, v12, v97
    v_and_b32 v75, v13, v97
    v_add_f32 v95, v95, v96
    s_waitcnt vmcnt(4)
    v_mfma_f32_16x16x32_bf16 v[84:87], v[72:75], v[216:219], v[84:87]
    buffer_load_dwordx4 v[236:239], v5, s[88:91], s55 offen offset:1792 nt
    s_waitcnt vmcnt(4)
    v_mfma_f32_16x16x32_bf16 v[88:91], v[72:75], v[220:223], v[88:91]
    s_add_u32 s55, s53, 32768
    buffer_load_dwordx4 v[240:243], v5, s[88:91], s55 offen offset:0 nt
    v_lshlrev_b32 v96, 16, v49
    v_fma_f32 v96, v96, s96, -v93
    v_exp_f32 v96, v96
    s_nop 0
    v_cvt_pk_bf16_f32 v97, v96, v96
    v_and_b32 v68, v10, v97
    v_and_b32 v69, v11, v97
    v_and_b32 v70, v12, v97
    v_and_b32 v71, v13, v97
    v_add_f32 v95, v95, v96
    s_waitcnt vmcnt(4)
    v_mfma_f32_16x16x32_bf16 v[84:87], v[68:71], v[224:227], v[84:87]
    buffer_load_dwordx4 v[244:247], v5, s[88:91], s55 offen offset:256 nt
    s_waitcnt vmcnt(4)
    v_mfma_f32_16x16x32_bf16 v[88:91], v[68:71], v[228:231], v[88:91]
    buffer_load_dwordx4 v[248:251], v5, s[88:91], s55 offen offset:512 nt
    v_and_b32 v96, s97, v49
    v_fma_f32 v96, v96, s96, -v93
    v_exp_f32 v96, v96
    s_nop 0
    v_cvt_pk_bf16_f32 v97, v96, v96
    v_and_b32 v72, v10, v97
    v_and_b32 v73, v11, v97
    v_and_b32 v74, v12, v97
    v_and_b32 v75, v13, v97
    v_add_f32 v95, v95, v96
    s_waitcnt vmcnt(4)
    v_mfma_f32_16x16x32_bf16 v[84:87], v[72:75], v[232:235], v[84:87]
    buffer_load_dwordx4 v[252:255], v5, s[88:91], s55 offen offset:768 nt
    s_waitcnt vmcnt(4)
    v_mfma_f32_16x16x32_bf16 v[88:91], v[72:75], v[236:239], v[88:91]
    buffer_load_dwordx4 v[100:103], v5, s[88:91], s55 offen offset:1024 nt
    v_lshlrev_b32 v96, 16, v50
    v_fma_f32 v96, v96, s96, -v93
    v_exp_f32 v96, v96
    s_nop 0
    v_cvt_pk_bf16_f32 v97, v96, v96
    v_and_b32 v68, v10, v97
    v_and_b32 v69, v11, v97
    v_and_b32 v70, v12, v97
    v_and_b32 v71, v13, v97
    v_add_f32 v95, v95, v96
    s_waitcnt vmcnt(4)
    v_mfma_f32_16x16x32_bf16 v[84:87], v[68:71], v[240:243], v[84:87]
    buffer_load_dwordx4 v[104:107], v5, s[88:91], s55 offen offset:1280 nt
    s_waitcnt vmcnt(4)
    v_mfma_f32_16x16x32_bf16 v[88:91], v[68:71], v[244:247], v[88:91]
    buffer_load_dwordx4 v[108:111], v5, s[88:91], s55 offen offset:1536 nt
    v_and_b32 v96, s97, v50
    v_fma_f32 v96, v96, s96, -v93
    v_exp_f32 v96, v96
    s_nop 0
    v_cvt_pk_bf16_f32 v97, v96, v96
    v_and_b32 v72, v10, v97
    v_and_b32 v73, v11, v97
    v_and_b32 v74, v12, v97
    v_and_b32 v75, v13, v97
    v_add_f32 v95, v95, v96
    s_waitcnt vmcnt(4)
    v_mfma_f32_16x16x32_bf16 v[84:87], v[72:75], v[248:251], v[84:87]
    buffer_load_dwordx4 v[112:115], v5, s[88:91], s55 offen offset:1792 nt
    s_waitcnt vmcnt(4)
    v_mfma_f32_16x16x32_bf16 v[88:91], v[72:75], v[252:255], v[88:91]
    s_add_u32 s55, s63, 0
    buffer_load_dwordx4 v[116:119], v6, s[92:95], s55 offen offset:0 nt
    v_lshlrev_b32 v96, 16, v51
    v_fma_f32 v96, v96, s96, -v93
    v_exp_f32 v96, v96
    s_nop 0
    v_cvt_pk_bf16_f32 v97, v96, v96
    v_and_b32 v68, v10, v97
    v_and_b32 v69, v11, v97
    v_and_b32 v70, v12, v97
    v_and_b32 v71, v13, v97
    v_add_f32 v95, v95, v96
    s_waitcnt vmcnt(4)
    v_mfma_f32_16x16x32_bf16 v[84:87], v[68:71], v[100:103], v[84:87]
    buffer_load_dwordx4 v[120:123], v6, s[92:95], s55 offen offset:896 nt
    s_waitcnt vmcnt(4)
    v_mfma_f32_16x16x32_bf16 v[88:91], v[68:71], v[104:107], v[88:91]
    buffer_load_dwordx4 v[124:127], v6, s[92:95], s55 offen offset:1792 nt
    v_and_b32 v96, s97, v51
    v_fma_f32 v96, v96, s96, -v93
    v_exp_f32 v96, v96
    s_nop 0
    v_cvt_pk_bf16_f32 v97, v96, v96
    v_and_b32 v72, v10, v97
    v_and_b32 v73, v11, v97
    v_and_b32 v74, v12, v97
    v_and_b32 v75, v13, v97
    v_add_f32 v95, v95, v96
    v_mov_b32 v96, v95
    s_nop 1
    v_permlane16_swap_b32 v95, v96
    s_nop 0
    v_add_f32 v95, v95, v96
    v_mov_b32 v96, v95
    s_nop 1
    v_permlane32_swap_b32 v95, v96
    s_nop 0
    v_add_f32 v95, v95, v96
    v_mov_b32 v98, v93
    v_mov_b32 v99, v95
    ds_write_b64 v60, v[98:99] offset:18496
    s_waitcnt vmcnt(4)
    v_mfma_f32_16x16x32_bf16 v[84:87], v[72:75], v[108:111], v[84:87]
    buffer_load_dwordx4 v[128:131], v6, s[92:95], s55 offen offset:2688 nt
    s_waitcnt vmcnt(4)
    v_mfma_f32_16x16x32_bf16 v[88:91], v[72:75], v[112:115], v[88:91]
    s_add_u32 s55, s63, 3584
    buffer_load_dwordx4 v[132:135], v6, s[92:95], s55 offen offset:0 nt
    buffer_load_dwordx4 v[136:139], v6, s[92:95], s55 offen offset:896 nt
    buffer_load_dwordx4 v[140:143], v6, s[92:95], s55 offen offset:1792 nt
    buffer_load_dwordx4 v[144:147], v6, s[92:95], s55 offen offset:2688 nt
    s_nop 6
    ds_write_b128 v59, v[84:87] offset:4096
    ds_write_b128 v59, v[88:91] offset:4608
    s_waitcnt lgkmcnt(0)
    s_barrier
    ds_read_b128 v[16:19], v62 offset:18432
    ds_read_b128 v[20:23], v62 offset:18448
    ds_read_b128 v[24:27], v61 offset:2048
    ds_read_b128 v[28:31], v61 offset:6144
    ds_read_b128 v[32:35], v61 offset:10240
    ds_read_b128 v[36:39], v61 offset:14336
    v_mov_b32 v47, v7
    s_mov_b32 s62, 100000
    s_waitcnt lgkmcnt(4)
    v_max3_f32 v40, v16, v18, v20
    v_max_f32 v40, v40, v22
    v_sub_f32 v16, v16, v40
    v_sub_f32 v18, v18, v40
    v_sub_f32 v20, v20, v40
    v_sub_f32 v22, v22, v40
    v_exp_f32 v16, v16
    v_exp_f32 v18, v18
    v_exp_f32 v20, v20
    v_exp_f32 v22, v22
    v_mul_f32 v41, v16, v17
    v_fmac_f32 v41, v18, v19
    v_fmac_f32 v41, v20, v21
    v_fmac_f32 v41, v22, v23
    v_rcp_f32 v42, v41
    v_log_f32 v43, v41
    s_waitcnt lgkmcnt(0)
    v_mul_f32 v48, v16, v24
    v_mul_f32 v49, v16, v25
    v_mul_f32 v50, v16, v26
    v_mul_f32 v51, v16, v27
    v_fmac_f32 v48, v18, v28
    v_fmac_f32 v49, v18, v29
    v_fmac_f32 v50, v18, v30
    v_fmac_f32 v51, v18, v31
    v_fmac_f32 v48, v20, v32
    v_fmac_f32 v49, v20, v33
    v_fmac_f32 v50, v20, v34
    v_fmac_f32 v51, v20, v35
    v_fmac_f32 v48, v22, v36
    v_fmac_f32 v49, v22, v37
    v_fmac_f32 v50, v22, v38
    v_fmac_f32 v51, v22, v39
    v_add_f32 v46, v40, v43
    v_mul_f32 v48, v48, v42
    v_mul_f32 v49, v49, v42
    v_mul_f32 v50, v50, v42
    v_mul_f32 v51, v51, v42
    v_cvt_pk_bf16_f32 v44, v48, v49
    v_cvt_pk_bf16_f32 v45, v50, v51
    s_cmp_eq_u32 s69, 2
    s_cbranch_scc1 L_h1_near
    buffer_store_dwordx4 v[44:47], v63, s[36:39], s5 offen sc1
    s_branch L_h1_sent
L_h1_near:
    buffer_store_dwordx4 v[44:47], v63, s[36:39], s5 offen
L_h1_sent:
    s_barrier
L_h1:
    buffer_load_dwordx4 v[16:19], v64, s[36:39], s10 offen sc1
    s_waitcnt vmcnt(0)
    v_cmp_ne_u32 vcc, v19, v7
    s_and_b64 exec, exec, vcc
    s_cbranch_scc0 L_h1_done
    s_sub_u32 s62, s62, 1
    s_cbranch_scc1 L_h1_done
    s_bcnt1_i32_b64 s99, exec
    s_lshr_b32 s99, s99, 2
L_h1_slp:
    s_sub_u32 s99, s99, 1
    s_cbranch_scc1 L_h1
    s_sleep 1
    s_branch L_h1_slp
L_h1_done:
    s_mov_b64 exec, -1
    v_max_f32_dpp v22, v18, v18 row_ror:2 row_mask:0xf bank_mask:0xf
    v_lshlrev_b32 v24, 16, v16
    v_and_b32 v25, s97, v16
    v_max_f32_dpp v22, v22, v22 row_ror:4 row_mask:0xf bank_mask:0xf
    v_lshlrev_b32 v26, 16, v17
    v_and_b32 v27, s97, v17
    v_max_f32_dpp v22, v22, v22 row_ror:8 row_mask:0xf bank_mask:0xf
    v_mov_b32 v32, v22
    s_nop 1
    v_permlane16_swap_b32 v22, v32
    s_nop 0
    v_max_f32 v22, v22, v32
    v_sub_f32 v28, v18, v22
    v_exp_f32 v28, v28
    s_nop 0
    v_mul_f32 v24, v28, v24
    v_mul_f32 v25, v28, v25
    v_mul_f32 v26, v28, v26
    v_mul_f32 v27, v28, v27
    v_add_f32_dpp v28, v28, v28 row_ror:2 row_mask:0xf bank_mask:0xf
    v_add_f32_dpp v24, v24, v24 row_ror:2 row_mask:0xf bank_mask:0xf
    v_add_f32_dpp v25, v25, v25 row_ror:2 row_mask:0xf bank_mask:0xf
    v_add_f32_dpp v26, v26, v26 row_ror:2 row_mask:0xf bank_mask:0xf
    v_add_f32_dpp v27, v27, v27 row_ror:2 row_mask:0xf bank_mask:0xf
    v_add_f32_dpp v28, v28, v28 row_ror:4 row_mask:0xf bank_mask:0xf
    v_add_f32_dpp v24, v24, v24 row_ror:4 row_mask:0xf bank_mask:0xf
    v_add_f32_dpp v25, v25, v25 row_ror:4 row_mask:0xf bank_mask:0xf
    v_add_f32_dpp v26, v26, v26 row_ror:4 row_mask:0xf bank_mask:0xf
    v_add_f32_dpp v27, v27, v27 row_ror:4 row_mask:0xf bank_mask:0xf
    v_add_f32_dpp v28, v28, v28 row_ror:8 row_mask:0xf bank_mask:0xf
    v_add_f32_dpp v24, v24, v24 row_ror:8 row_mask:0xf bank_mask:0xf
    v_add_f32_dpp v25, v25, v25 row_ror:8 row_mask:0xf bank_mask:0xf
    v_add_f32_dpp v26, v26, v26 row_ror:8 row_mask:0xf bank_mask:0xf
    v_add_f32_dpp v27, v27, v27 row_ror:8 row_mask:0xf bank_mask:0xf
    v_mov_b32 v32, v28
    v_mov_b32 v33, v24
    v_mov_b32 v34, v25
    v_mov_b32 v35, v26
    v_mov_b32 v36, v27
    v_permlane16_swap_b32 v28, v32
    v_permlane16_swap_b32 v24, v33
    v_permlane16_swap_b32 v25, v34
    v_permlane16_swap_b32 v26, v35
    v_permlane16_swap_b32 v27, v36
    v_add_f32 v28, v28, v32
    v_rcp_f32 v28, v28
    v_add_f32 v24, v24, v33
    v_add_f32 v25, v25, v34
    v_add_f32 v26, v26, v35
    v_add_f32 v27, v27, v36
    s_mov_b32 exec_lo, 3
    s_mov_b32 exec_hi, 3
    v_mul_f32 v24, v28, v24
    v_mul_f32 v25, v28, v25
    v_mul_f32 v26, v28, v26
    v_mul_f32 v27, v28, v27
    v_cvt_pk_bf16_f32 v24, v24, v24
    v_cvt_pk_bf16_f32 v25, v25, v25
    v_cvt_pk_bf16_f32 v26, v26, v26
    v_cvt_pk_bf16_f32 v27, v27, v27
    ds_write_b128 v65, v[24:27] offset:18560
    s_mov_b64 exec, -1
    s_waitcnt lgkmcnt(0)
    s_barrier
    ds_read_b128 v[24:27], v66 offset:18560
    ds_read_b128 v[28:31], v66 offset:18576
    s_waitcnt lgkmcnt(1)
    v_and_b32 v68, v10, v24
    v_and_b32 v69, v11, v24
    v_and_b32 v70, v12, v24
    v_and_b32 v71, v13, v24
    v_and_b32 v72, v10, v25
    v_and_b32 v73, v11, v25
    v_and_b32 v74, v12, v25
    v_and_b32 v75, v13, v25
    v_mfma_f32_16x16x32_bf16 v[44:47], v[68:71], v[116:119], 0
    v_and_b32 v76, v10, v26
    v_and_b32 v77, v11, v26
    v_and_b32 v78, v12, v26
    v_and_b32 v79, v13, v26
    v_mfma_f32_16x16x32_bf16 v[44:47], v[72:75], v[120:123], v[44:47]
    v_and_b32 v80, v10, v27
    v_and_b32 v81, v11, v27
    v_and_b32 v82, v12, v27
    v_and_b32 v83, v13, v27
    v_mfma_f32_16x16x32_bf16 v[44:47], v[76:79], v[124:127], v[44:47]
    s_waitcnt lgkmcnt(0)
    v_and_b32 v84, v10, v28
    v_and_b32 v85, v11, v28
    v_and_b32 v86, v12, v28
    v_and_b32 v87, v13, v28
    v_mfma_f32_16x16x32_bf16 v[44:47], v[80:83], v[128:131], v[44:47]
    v_and_b32 v88, v10, v29
    v_and_b32 v89, v11, v29
    v_and_b32 v90, v12, v29
    v_and_b32 v91, v13, v29
    v_mfma_f32_16x16x32_bf16 v[44:47], v[84:87], v[132:135], v[44:47]
    v_and_b32 v68, v10, v30
    v_and_b32 v69, v11, v30
    v_and_b32 v70, v12, v30
    v_and_b32 v71, v13, v30
    v_mfma_f32_16x16x32_bf16 v[44:47], v[88:91], v[136:139], v[44:47]
    v_and_b32 v72, v10, v31
    v_and_b32 v73, v11, v31
    v_and_b32 v74, v12, v31
    v_and_b32 v75, v13, v31
    v_mfma_f32_16x16x32_bf16 v[44:47], v[68:71], v[140:143], v[44:47]
    s_nop 1
    v_mfma_f32_16x16x32_bf16 v[44:47], v[72:75], v[144:147], v[44:47]
    s_nop 7
    v_perm_b32 v44, v44, v7, s56
    v_perm_b32 v45, v45, v7, s57
    v_perm_b32 v46, v46, v7, s58
    v_perm_b32 v47, v47, v7, s59
    buffer_store_dwordx4 v[44:47], v67, s[36:39], s11 offen sc1
    s_cmp_ge_u32 s2, 56
    s_cbranch_scc1 L_send
    v_lshrrev_b32 v8, 3, v0
    v_lshlrev_b32 v4, 9, v8
    v_and_b32 v9, 7, v0
    v_lshl_add_u32 v4, v9, 4, v4
    s_lshl_b32 s14, s2, 14
    s_lshl_b32 s54, s3, 12
    s_add_u32 s14, s14, s54
    s_add_u32 s14, s14, 0x200000
    v_lshlrev_b32 v5, 4, v9
    s_lshl_b32 s54, s3, 7
    v_add_u32 v6, s54, v5
    v_lshlrev_b32 v15, 3, v9
    s_mul_i32 s52, s2, 4682
    s_lshr_b32 s52, s52, 16
    s_mul_i32 s53, s52, 14
    s_sub_u32 s53, s2, s53
    s_lshl_b32 s53, s53, 6
    s_and_b32 s54, s52, 1
    s_mul_i32 s54, s54, 1792
    s_add_u32 s53, s53, s54
    s_lshr_b32 s54, s52, 1
    s_mul_i32 s54, s54, 896
    s_add_u32 s53, s53, s54
    s_mov_b32 s40, s24
    s_mov_b32 s41, s25
    s_mov_b32 s42, 0xe00
    s_mov_b32 s43, 0x20000
    s_mov_b32 s62, 100000
    s_sleep 8
L_h2:
    buffer_load_dwordx4 v[16:19], v4, s[36:39], s14 offen offset:0 sc1
    buffer_load_dwordx4 v[20:23], v4, s[36:39], s14 offen offset:128 sc1
    buffer_load_dwordx4 v[24:27], v4, s[36:39], s14 offen offset:256 sc1
    buffer_load_dwordx4 v[28:31], v4, s[36:39], s14 offen offset:384 sc1
    s_waitcnt vmcnt(0)
    v_perm_b32 v33, v17, v16, s60
    v_perm_b32 v34, v19, v18, s61
    v_bitop3_b32 v32, v33, v34, v7 bitop3:0x56
    v_perm_b32 v33, v21, v20, s60
    v_perm_b32 v34, v23, v22, s61
    v_bitop3_b32 v33, v33, v34, v7 bitop3:0x56
    v_or_b32 v32, v32, v33
    v_perm_b32 v33, v25, v24, s60
    v_perm_b32 v34, v27, v26, s61
    v_bitop3_b32 v33, v33, v34, v7 bitop3:0x56
    v_or_b32 v32, v32, v33
    v_perm_b32 v33, v29, v28, s60
    v_perm_b32 v34, v31, v30, s61
    v_bitop3_b32 v33, v33, v34, v7 bitop3:0x56
    v_or_b32 v32, v32, v33
    v_cmp_ne_u32 vcc, 0, v32
    s_and_b64 exec, exec, vcc
    s_cbranch_scc0 L_h2_done
    s_sub_u32 s62, s62, 1
    s_cbranch_scc1 L_h2_done
    s_bcnt1_i32_b64 s99, exec
    s_lshr_b32 s99, s99, 4
L_h2_slp:
    s_sub_u32 s99, s99, 1
    s_cbranch_scc1 L_h2
    s_sleep 1
    s_branch L_h2_slp
L_h2_done:
    s_mov_b64 exec, -1
    v_add_f32 v16, v16, v20
    v_add_f32 v24, v24, v28
    v_add_f32 v17, v17, v21
    v_add_f32 v25, v25, v29
    v_add_f32 v18, v18, v22
    v_add_f32 v26, v26, v30
    v_add_f32 v19, v19, v23
    v_add_f32 v27, v27, v31
    v_add_f32 v16, v16, v24
    v_add_f32 v17, v17, v25
    v_add_f32 v18, v18, v26
    v_add_f32 v19, v19, v27
    v_add_f32_dpp v16, v16, v16 row_ror:8 row_mask:0xf bank_mask:0xf
    v_add_f32_dpp v17, v17, v17 row_ror:8 row_mask:0xf bank_mask:0xf
    v_add_f32_dpp v18, v18, v18 row_ror:8 row_mask:0xf bank_mask:0xf
    v_add_f32_dpp v19, v19, v19 row_ror:8 row_mask:0xf bank_mask:0xf
    v_mov_b32 v20, v16
    v_mov_b32 v21, v17
    v_mov_b32 v22, v18
    v_mov_b32 v23, v19
    v_permlane16_swap_b32 v16, v20
    v_permlane16_swap_b32 v17, v21
    v_permlane16_swap_b32 v18, v22
    v_permlane16_swap_b32 v19, v23
    v_add_f32 v16, v16, v20
    v_add_f32 v17, v17, v21
    v_add_f32 v18, v18, v22
    v_add_f32 v19, v19, v23
    v_mov_b32 v20, v16
    v_mov_b32 v21, v17
    v_mov_b32 v22, v18
    v_mov_b32 v23, v19
    v_permlane32_swap_b32 v16, v20
    v_permlane32_swap_b32 v17, v21
    v_permlane32_swap_b32 v18, v22
    v_permlane32_swap_b32 v19, v23
    v_add_f32 v16, v16, v20
    v_add_f32 v17, v17, v21
    v_add_f32 v18, v18, v22
    v_add_f32 v19, v19, v23
    s_mov_b64 exec, 0xff
    ds_write_b128 v6, v[16:19] offset:0
    s_waitcnt lgkmcnt(0)
    s_barrier
    s_cmp_lg_u32 s3, 0
    s_cbranch_scc1 L_end
    ds_read_b128 v[20:23], v5 offset:128
    ds_read_b128 v[24:27], v5 offset:256
    ds_read_b128 v[28:31], v5 offset:384
    s_waitcnt lgkmcnt(0)
    v_add_f32 v16, v16, v20
    v_add_f32 v24, v24, v28
    v_add_f32 v17, v17, v21
    v_add_f32 v25, v25, v29
    v_add_f32 v18, v18, v22
    v_add_f32 v26, v26, v30
    v_add_f32 v19, v19, v23
    v_add_f32 v27, v27, v31
    v_add_f32 v16, v16, v24
    v_add_f32 v17, v17, v25
    v_add_f32 v18, v18, v26
    v_add_f32 v19, v19, v27
    v_cvt_pk_bf16_f32 v16, v16, v17
    v_cvt_pk_bf16_f32 v17, v18, v19
    buffer_store_dwordx2 v[16:17], v15, s[40:43], s53 offen sc0 sc1
    s_cmp_lg_u32 s2, 0
    s_cbranch_scc1 L_send2
    s_mov_b64 exec, 1
    buffer_store_dword v7, v15, s[36:39], 0 offen sc1
L_send2:
L_send:
    s_endpgm
L_helper:
    s_setprio 3
    v_mov_b32 v8, 0
    ds_write_b32 v8, v8 offset:18816
    v_bfe_u32 v8, v0, 3, 1
    v_mul_u32_u24 v4, 896, v8
    v_mul_u32_u24 v8, 56, v3
    v_add_u32 v4, v4, v8
    v_mul_u32_u24 v5, 229376, v3
    v_lshl_add_u32 v5, v2, 4, v5
    s_and_b32 s35, s34, 3
    s_mul_i32 s52, s35, 224
    s_mul_i32 s53, s35, 917504
    s_lshl_b32 s54, s31, 10
    s_add_u32 s53, s53, s54
    s_bfe_u32 s54, s34, 0x20002
    s_lshl_b32 s54, s54, 8
    s_add_u32 s53, s53, s54
    s_cmp_ge_u32 s34, 16
    s_waitcnt lgkmcnt(0)
    s_cselect_b32 s40, s14, s4
    s_cselect_b32 s41, s15, s5
    s_mov_b32 s42, 1792
    s_mov_b32 s43, 0x20000
    s_cselect_b32 s44, s20, s10
    s_cselect_b32 s45, s21, s11
    s_mov_b32 s46, 0x380000
    s_mov_b32 s47, 0x20000
    buffer_load_dwordx4 v[16:19], v4, s[40:43], s52 offen
    buffer_load_dwordx4 v[20:23], v4, s[40:43], s52 offen offset:16
    buffer_load_dwordx4 v[24:27], v4, s[40:43], s52 offen offset:32
    buffer_load_dwordx2 v[28:29], v4, s[40:43], s52 offen offset:48
    buffer_load_dwordx4 v[64:67], v5, s[44:47], s53 offen nt
    s_add_u32 s53, s53, 8192
    buffer_load_dwordx4 v[68:71], v5, s[44:47], s53 offen nt
    s_add_u32 s53, s53, 8192
    buffer_load_dwordx4 v[72:75], v5, s[44:47], s53 offen nt
    s_add_u32 s53, s53, 8192
    buffer_load_dwordx4 v[76:79], v5, s[44:47], s53 offen nt
    s_add_u32 s53, s53, 8192
    buffer_load_dwordx4 v[80:83], v5, s[44:47], s53 offen nt
    s_add_u32 s53, s53, 8192
    buffer_load_dwordx4 v[84:87], v5, s[44:47], s53 offen nt
    s_add_u32 s53, s53, 8192
    buffer_load_dwordx4 v[88:91], v5, s[44:47], s53 offen nt
    s_add_u32 s53, s53, 8192
    buffer_load_dwordx4 v[92:95], v5, s[44:47], s53 offen nt
    s_add_u32 s53, s53, 8192
    buffer_load_dwordx4 v[96:99], v5, s[44:47], s53 offen nt
    s_add_u32 s53, s53, 8192
    buffer_load_dwordx4 v[100:103], v5, s[44:47], s53 offen nt
    s_add_u32 s53, s53, 8192
    buffer_load_dwordx4 v[104:107], v5, s[44:47], s53 offen nt
    s_add_u32 s53, s53, 8192
    buffer_load_dwordx4 v[108:111], v5, s[44:47], s53 offen nt
    s_add_u32 s53, s53, 8192
    buffer_load_dwordx4 v[112:115], v5, s[44:47], s53 offen nt
    s_add_u32 s53, s53, 8192
    buffer_load_dwordx4 v[116:119], v5, s[44:47], s53 offen nt
    s_add_u32 s53, s53, 8192
    buffer_load_dwordx4 v[120:123], v5, s[44:47], s53 offen nt
    s_add_u32 s53, s53, 8192
    buffer_load_dwordx4 v[124:127], v5, s[44:47], s53 offen nt
    s_add_u32 s53, s53, 8192
    buffer_load_dwordx4 v[128:131], v5, s[44:47], s53 offen nt
    s_add_u32 s53, s53, 8192
    buffer_load_dwordx4 v[132:135], v5, s[44:47], s53 offen nt
    s_add_u32 s53, s53, 8192
    buffer_load_dwordx4 v[136:139], v5, s[44:47], s53 offen nt
    s_add_u32 s53, s53, 8192
    buffer_load_dwordx4 v[140:143], v5, s[44:47], s53 offen nt
    s_add_u32 s53, s53, 8192
    buffer_load_dwordx4 v[144:147], v5, s[44:47], s53 offen nt
    s_add_u32 s53, s53, 8192
    buffer_load_dwordx4 v[148:151], v5, s[44:47], s53 offen nt
    s_add_u32 s53, s53, 8192
    buffer_load_dwordx4 v[152:155], v5, s[44:47], s53 offen nt
    s_add_u32 s53, s53, 8192
    buffer_load_dwordx4 v[156:159], v5, s[44:47], s53 offen nt
    s_add_u32 s53, s53, 8192
    buffer_load_dwordx4 v[160:163], v5, s[44:47], s53 offen nt
    s_add_u32 s53, s53, 8192
    buffer_load_dwordx4 v[164:167], v5, s[44:47], s53 offen nt
    s_add_u32 s53, s53, 8192
    buffer_load_dwordx4 v[168:171], v5, s[44:47], s53 offen nt
    s_add_u32 s53, s53, 8192
    buffer_load_dwordx4 v[172:175], v5, s[44:47], s53 offen nt
    s_barrier
    s_load_dword s30, s[28:29], 0
    s_mov_b32 s36, s28
    s_mov_b32 s37, s29
    s_mov_b32 s38, 0x400000
    s_mov_b32 s39, 0x20000
    v_and_b32 v8, 1, v0
    v_lshlrev_b32 v8, 4, v8
    v_mov_b32 v9, 0xffff
    v_lshlrev_b32 v9, v8, v9
    v_bfe_u32 v8, v0, 1, 2
    v_cmp_eq_u32 vcc, 0, v8
    s_nop 1
    v_cndmask_b32 v10, 0, v9, vcc
    v_cmp_eq_u32 vcc, 1, v8
    s_nop 1
    v_cndmask_b32 v11, 0, v9, vcc
    v_cmp_eq_u32 vcc, 2, v8
    s_nop 1
    v_cndmask_b32 v12, 0, v9, vcc
    v_cmp_eq_u32 vcc, 3, v8
    s_nop 1
    v_cndmask_b32 v13, 0, v9, vcc
    s_mov_b32 s48, 0x01000100
    s_mov_b32 s49, 0x03020302
    v_lshrrev_b32 v8, 5, v0
    v_lshlrev_b32 v6, 14, v8
    v_lshl_add_u32 v6, v2, 5, v6
    v_and_b32 v9, 1, v3
    v_lshl_add_u32 v6, v9, 4, v6
    s_lshl_b32 s50, s31, 15
    s_lshl_b32 s54, s34, 9
    s_add_u32 s50, s50, s54
    s_add_u32 s50, s50, 0x1000
    v_lshlrev_b32 v14, 11, v8
    v_and_b32 v9, 31, v0
    v_lshl_add_u32 v14, v9, 4, v14
    s_lshl_b32 s51, s31, 1
    s_add_u32 s51, s51, s32
    s_lshl_b32 s51, s51, 14
    s_add_u32 s51, s51, 0x1000
    v_lshlrev_b32 v15, 3, v0
    s_waitcnt lgkmcnt(0)
    s_add_u32 s30, s30, 0x3b5d7f91
    s_mov_b32 s56, 0x7060500
    s_mov_b32 s57, 0x7060501
    s_mov_b32 s58, 0x7060502
    s_mov_b32 s59, 0x7060503
    s_mov_b32 s60, 0x0c0c0400
    s_mov_b32 s61, 0x04000c0c
    v_mov_b32 v7, s30
    s_waitcnt vmcnt(28)
    v_perm_b32 v8, v16, v16, s48
    v_and_b32 v36, v10, v8
    v_and_b32 v37, v11, v8
    v_and_b32 v38, v12, v8
    v_and_b32 v39, v13, v8
    v_perm_b32 v8, v16, v16, s49
    v_and_b32 v40, v10, v8
    v_and_b32 v41, v11, v8
    v_and_b32 v42, v12, v8
    v_and_b32 v43, v13, v8
    s_waitcnt vmcnt(27)
    v_mfma_f32_16x16x32_bf16 v[32:35], v[36:39], v[64:67], 0
    v_perm_b32 v8, v17, v17, s48
    v_and_b32 v36, v10, v8
    v_and_b32 v37, v11, v8
    v_and_b32 v38, v12, v8
    v_and_b32 v39, v13, v8
    s_waitcnt vmcnt(26)
    v_mfma_f32_16x16x32_bf16 v[32:35], v[40:43], v[68:71], v[32:35]
    v_perm_b32 v8, v17, v17, s49
    v_and_b32 v40, v10, v8
    v_and_b32 v41, v11, v8
    v_and_b32 v42, v12, v8
    v_and_b32 v43, v13, v8
    s_waitcnt vmcnt(25)
    v_mfma_f32_16x16x32_bf16 v[32:35], v[36:39], v[72:75], v[32:35]
    v_perm_b32 v8, v18, v18, s48
    v_and_b32 v36, v10, v8
    v_and_b32 v37, v11, v8
    v_and_b32 v38, v12, v8
    v_and_b32 v39, v13, v8
    s_waitcnt vmcnt(24)
    v_mfma_f32_16x16x32_bf16 v[32:35], v[40:43], v[76:79], v[32:35]
    v_perm_b32 v8, v18, v18, s49
    v_and_b32 v40, v10, v8
    v_and_b32 v41, v11, v8
    v_and_b32 v42, v12, v8
    v_and_b32 v43, v13, v8
    s_waitcnt vmcnt(23)
    v_mfma_f32_16x16x32_bf16 v[32:35], v[36:39], v[80:83], v[32:35]
    v_perm_b32 v8, v19, v19, s48
    v_and_b32 v36, v10, v8
    v_and_b32 v37, v11, v8
    v_and_b32 v38, v12, v8
    v_and_b32 v39, v13, v8
    s_waitcnt vmcnt(22)
    v_mfma_f32_16x16x32_bf16 v[32:35], v[40:43], v[84:87], v[32:35]
    v_perm_b32 v8, v19, v19, s49
    v_and_b32 v40, v10, v8
    v_and_b32 v41, v11, v8
    v_and_b32 v42, v12, v8
    v_and_b32 v43, v13, v8
    s_waitcnt vmcnt(21)
    v_mfma_f32_16x16x32_bf16 v[32:35], v[36:39], v[88:91], v[32:35]
    v_perm_b32 v8, v20, v20, s48
    v_and_b32 v36, v10, v8
    v_and_b32 v37, v11, v8
    v_and_b32 v38, v12, v8
    v_and_b32 v39, v13, v8
    s_waitcnt vmcnt(20)
    v_mfma_f32_16x16x32_bf16 v[32:35], v[40:43], v[92:95], v[32:35]
    v_perm_b32 v8, v20, v20, s49
    v_and_b32 v40, v10, v8
    v_and_b32 v41, v11, v8
    v_and_b32 v42, v12, v8
    v_and_b32 v43, v13, v8
    s_waitcnt vmcnt(19)
    v_mfma_f32_16x16x32_bf16 v[32:35], v[36:39], v[96:99], v[32:35]
    v_perm_b32 v8, v21, v21, s48
    v_and_b32 v36, v10, v8
    v_and_b32 v37, v11, v8
    v_and_b32 v38, v12, v8
    v_and_b32 v39, v13, v8
    s_waitcnt vmcnt(18)
    v_mfma_f32_16x16x32_bf16 v[32:35], v[40:43], v[100:103], v[32:35]
    v_perm_b32 v8, v21, v21, s49
    v_and_b32 v40, v10, v8
    v_and_b32 v41, v11, v8
    v_and_b32 v42, v12, v8
    v_and_b32 v43, v13, v8
    s_waitcnt vmcnt(17)
    v_mfma_f32_16x16x32_bf16 v[32:35], v[36:39], v[104:107], v[32:35]
    v_perm_b32 v8, v22, v22, s48
    v_and_b32 v36, v10, v8
    v_and_b32 v37, v11, v8
    v_and_b32 v38, v12, v8
    v_and_b32 v39, v13, v8
    s_waitcnt vmcnt(16)
    v_mfma_f32_16x16x32_bf16 v[32:35], v[40:43], v[108:111], v[32:35]
    v_perm_b32 v8, v22, v22, s49
    v_and_b32 v40, v10, v8
    v_and_b32 v41, v11, v8
    v_and_b32 v42, v12, v8
    v_and_b32 v43, v13, v8
    s_waitcnt vmcnt(15)
    v_mfma_f32_16x16x32_bf16 v[32:35], v[36:39], v[112:115], v[32:35]
    v_perm_b32 v8, v23, v23, s48
    v_and_b32 v36, v10, v8
    v_and_b32 v37, v11, v8
    v_and_b32 v38, v12, v8
    v_and_b32 v39, v13, v8
    s_waitcnt vmcnt(14)
    v_mfma_f32_16x16x32_bf16 v[32:35], v[40:43], v[116:119], v[32:35]
    v_perm_b32 v8, v23, v23, s49
    v_and_b32 v40, v10, v8
    v_and_b32 v41, v11, v8
    v_and_b32 v42, v12, v8
    v_and_b32 v43, v13, v8
    s_waitcnt vmcnt(13)
    v_mfma_f32_16x16x32_bf16 v[32:35], v[36:39], v[120:123], v[32:35]
    v_perm_b32 v8, v24, v24, s48
    v_and_b32 v36, v10, v8
    v_and_b32 v37, v11, v8
    v_and_b32 v38, v12, v8
    v_and_b32 v39, v13, v8
    s_waitcnt vmcnt(12)
    v_mfma_f32_16x16x32_bf16 v[32:35], v[40:43], v[124:127], v[32:35]
    v_perm_b32 v8, v24, v24, s49
    v_and_b32 v40, v10, v8
    v_and_b32 v41, v11, v8
    v_and_b32 v42, v12, v8
    v_and_b32 v43, v13, v8
    s_waitcnt vmcnt(11)
    v_mfma_f32_16x16x32_bf16 v[32:35], v[36:39], v[128:131], v[32:35]
    v_perm_b32 v8, v25, v25, s48
    v_and_b32 v36, v10, v8
    v_and_b32 v37, v11, v8
    v_and_b32 v38, v12, v8
    v_and_b32 v39, v13, v8
    s_waitcnt vmcnt(10)
    v_mfma_f32_16x16x32_bf16 v[32:35], v[40:43], v[132:135], v[32:35]
    v_perm_b32 v8, v25, v25, s49
    v_and_b32 v40, v10, v8
    v_and_b32 v41, v11, v8
    v_and_b32 v42, v12, v8
    v_and_b32 v43, v13, v8
    s_waitcnt vmcnt(9)
    v_mfma_f32_16x16x32_bf16 v[32:35], v[36:39], v[136:139], v[32:35]
    v_perm_b32 v8, v26, v26, s48
    v_and_b32 v36, v10, v8
    v_and_b32 v37, v11, v8
    v_and_b32 v38, v12, v8
    v_and_b32 v39, v13, v8
    s_waitcnt vmcnt(8)
    v_mfma_f32_16x16x32_bf16 v[32:35], v[40:43], v[140:143], v[32:35]
    v_perm_b32 v8, v26, v26, s49
    v_and_b32 v40, v10, v8
    v_and_b32 v41, v11, v8
    v_and_b32 v42, v12, v8
    v_and_b32 v43, v13, v8
    s_waitcnt vmcnt(7)
    v_mfma_f32_16x16x32_bf16 v[32:35], v[36:39], v[144:147], v[32:35]
    v_perm_b32 v8, v27, v27, s48
    v_and_b32 v36, v10, v8
    v_and_b32 v37, v11, v8
    v_and_b32 v38, v12, v8
    v_and_b32 v39, v13, v8
    s_waitcnt vmcnt(6)
    v_mfma_f32_16x16x32_bf16 v[32:35], v[40:43], v[148:151], v[32:35]
    v_perm_b32 v8, v27, v27, s49
    v_and_b32 v40, v10, v8
    v_and_b32 v41, v11, v8
    v_and_b32 v42, v12, v8
    v_and_b32 v43, v13, v8
    s_waitcnt vmcnt(5)
    v_mfma_f32_16x16x32_bf16 v[32:35], v[36:39], v[152:155], v[32:35]
    v_perm_b32 v8, v28, v28, s48
    v_and_b32 v36, v10, v8
    v_and_b32 v37, v11, v8
    v_and_b32 v38, v12, v8
    v_and_b32 v39, v13, v8
    s_waitcnt vmcnt(4)
    v_mfma_f32_16x16x32_bf16 v[32:35], v[40:43], v[156:159], v[32:35]
    v_perm_b32 v8, v28, v28, s49
    v_and_b32 v40, v10, v8
    v_and_b32 v41, v11, v8
    v_and_b32 v42, v12, v8
    v_and_b32 v43, v13, v8
    s_waitcnt vmcnt(3)
    v_mfma_f32_16x16x32_bf16 v[32:35], v[36:39], v[160:163], v[32:35]
    v_perm_b32 v8, v29, v29, s48
    v_and_b32 v36, v10, v8
    v_and_b32 v37, v11, v8
    v_and_b32 v38, v12, v8
    v_and_b32 v39, v13, v8
    s_waitcnt vmcnt(2)
    v_mfma_f32_16x16x32_bf16 v[32:35], v[40:43], v[164:167], v[32:35]
    v_perm_b32 v8, v29, v29, s49
    v_and_b32 v40, v10, v8
    v_and_b32 v41, v11, v8
    v_and_b32 v42, v12, v8
    v_and_b32 v43, v13, v8
    s_waitcnt vmcnt(1)
    v_mfma_f32_16x16x32_bf16 v[32:35], v[36:39], v[168:171], v[32:35]
    s_nop 1
    s_waitcnt vmcnt(0)
    v_mfma_f32_16x16x32_bf16 v[32:35], v[40:43], v[172:175], v[32:35]
    s_getreg_b32 s63, hwreg(HW_REG_XCC_ID, 0, 4)
    v_xor_b32 v7, s63, v7
    s_nop 7
    v_perm_b32 v32, v32, v7, s56
    v_perm_b32 v33, v33, v7, s57
    v_perm_b32 v34, v34, v7, s58
    v_perm_b32 v35, v35, v7, s59
    buffer_store_dwordx4 v[32:35], v6, s[36:39], s50 offen
    s_mov_b32 s62, 100000
    s_sleep 30
    s_mov_b32 s35, 0xffff
L_h0:
    s_add_u32 s54, s51, 0
    s_bitcmp0_b32 s35, 0
    s_cbranch_scc1 L_h0s0
    buffer_load_dwordx4 v[64:67], v14, s[36:39], s54 offen offset:0 sc1
L_h0s0:
    s_bitcmp0_b32 s35, 1
    s_cbranch_scc1 L_h0s1
    buffer_load_dwordx4 v[68:71], v14, s[36:39], s54 offen offset:512 sc1
L_h0s1:
    s_bitcmp0_b32 s35, 2
    s_cbranch_scc1 L_h0s2
    buffer_load_dwordx4 v[72:75], v14, s[36:39], s54 offen offset:1024 sc1
L_h0s2:
    s_bitcmp0_b32 s35, 3
    s_cbranch_scc1 L_h0s3
    buffer_load_dwordx4 v[76:79], v14, s[36:39], s54 offen offset:1536 sc1
L_h0s3:
    s_add_u32 s54, s51, 4096
    s_bitcmp0_b32 s35, 4
    s_cbranch_scc1 L_h0s4
    buffer_load_dwordx4 v[80:83], v14, s[36:39], s54 offen offset:0 sc1
L_h0s4:
    s_bitcmp0_b32 s35, 5
    s_cbranch_scc1 L_h0s5
    buffer_load_dwordx4 v[84:87], v14, s[36:39], s54 offen offset:512 sc1
L_h0s5:
    s_bitcmp0_b32 s35, 6
    s_cbranch_scc1 L_h0s6
    buffer_load_dwordx4 v[88:91], v14, s[36:39], s54 offen offset:1024 sc1
L_h0s6:
    s_bitcmp0_b32 s35, 7
    s_cbranch_scc1 L_h0s7
    buffer_load_dwordx4 v[92:95], v14, s[36:39], s54 offen offset:1536 sc1
L_h0s7:
    s_add_u32 s54, s51, 8192
    s_bitcmp0_b32 s35, 8
    s_cbranch_scc1 L_h0s8
    buffer_load_dwordx4 v[96:99], v14, s[36:39], s54 offen offset:0 sc1
L_h0s8:
    s_bitcmp0_b32 s35, 9
    s_cbranch_scc1 L_h0s9
    buffer_load_dwordx4 v[100:103], v14, s[36:39], s54 offen offset:512 sc1
L_h0s9:
    s_bitcmp0_b32 s35, 10
    s_cbranch_scc1 L_h0s10
    buffer_load_dwordx4 v[104:107], v14, s[36:39], s54 offen offset:1024 sc1
L_h0s10:
    s_bitcmp0_b32 s35, 11
    s_cbranch_scc1 L_h0s11
    buffer_load_dwordx4 v[108:111], v14, s[36:39], s54 offen offset:1536 sc1
L_h0s11:
    s_add_u32 s54, s51, 12288
    s_bitcmp0_b32 s35, 12
    s_cbranch_scc1 L_h0s12
    buffer_load_dwordx4 v[112:115], v14, s[36:39], s54 offen offset:0 sc1
L_h0s12:
    s_bitcmp0_b32 s35, 13
    s_cbranch_scc1 L_h0s13
    buffer_load_dwordx4 v[116:119], v14, s[36:39], s54 offen offset:512 sc1
L_h0s13:
    s_bitcmp0_b32 s35, 14
    s_cbranch_scc1 L_h0s14
    buffer_load_dwordx4 v[120:123], v14, s[36:39], s54 offen offset:1024 sc1
L_h0s14:
    s_bitcmp0_b32 s35, 15
    s_cbranch_scc1 L_h0s15
    buffer_load_dwordx4 v[124:127], v14, s[36:39], s54 offen offset:1536 sc1
L_h0s15:
    s_waitcnt vmcnt(0)
    s_mov_b32 s35, 0
    v_perm_b32 v45, v65, v64, s60
    v_perm_b32 v46, v67, v66, s61
    v_bitop3_b32 v128, v45, v46, v7 bitop3:0x56
    v_cmp_lt_u32 vcc, 15, v128
    s_cmp_lg_u64 vcc, 0
    s_cselect_b32 s54, 1, 0
    s_or_b32 s35, s35, s54
    v_perm_b32 v45, v69, v68, s60
    v_perm_b32 v46, v71, v70, s61
    v_bitop3_b32 v129, v45, v46, v7 bitop3:0x56
    v_cmp_lt_u32 vcc, 15, v129
    s_cmp_lg_u64 vcc, 0
    s_cselect_b32 s54, 2, 0
    s_or_b32 s35, s35, s54
    v_perm_b32 v45, v73, v72, s60
    v_perm_b32 v46, v75, v74, s61
    v_bitop3_b32 v130, v45, v46, v7 bitop3:0x56
    v_cmp_lt_u32 vcc, 15, v130
    s_cmp_lg_u64 vcc, 0
    s_cselect_b32 s54, 4, 0
    s_or_b32 s35, s35, s54
    v_perm_b32 v45, v77, v76, s60
    v_perm_b32 v46, v79, v78, s61
    v_bitop3_b32 v131, v45, v46, v7 bitop3:0x56
    v_cmp_lt_u32 vcc, 15, v131
    s_cmp_lg_u64 vcc, 0
    s_cselect_b32 s54, 8, 0
    s_or_b32 s35, s35, s54
    v_perm_b32 v45, v81, v80, s60
    v_perm_b32 v46, v83, v82, s61
    v_bitop3_b32 v132, v45, v46, v7 bitop3:0x56
    v_cmp_lt_u32 vcc, 15, v132
    s_cmp_lg_u64 vcc, 0
    s_cselect_b32 s54, 16, 0
    s_or_b32 s35, s35, s54
    v_perm_b32 v45, v85, v84, s60
    v_perm_b32 v46, v87, v86, s61
    v_bitop3_b32 v133, v45, v46, v7 bitop3:0x56
    v_cmp_lt_u32 vcc, 15, v133
    s_cmp_lg_u64 vcc, 0
    s_cselect_b32 s54, 32, 0
    s_or_b32 s35, s35, s54
    v_perm_b32 v45, v89, v88, s60
    v_perm_b32 v46, v91, v90, s61
    v_bitop3_b32 v134, v45, v46, v7 bitop3:0x56
    v_cmp_lt_u32 vcc, 15, v134
    s_cmp_lg_u64 vcc, 0
    s_cselect_b32 s54, 64, 0
    s_or_b32 s35, s35, s54
    v_perm_b32 v45, v93, v92, s60
    v_perm_b32 v46, v95, v94, s61
    v_bitop3_b32 v135, v45, v46, v7 bitop3:0x56
    v_cmp_lt_u32 vcc, 15, v135
    s_cmp_lg_u64 vcc, 0
    s_cselect_b32 s54, 128, 0
    s_or_b32 s35, s35, s54
    v_perm_b32 v45, v97, v96, s60
    v_perm_b32 v46, v99, v98, s61
    v_bitop3_b32 v136, v45, v46, v7 bitop3:0x56
    v_cmp_lt_u32 vcc, 15, v136
    s_cmp_lg_u64 vcc, 0
    s_cselect_b32 s54, 256, 0
    s_or_b32 s35, s35, s54
    v_perm_b32 v45, v101, v100, s60
    v_perm_b32 v46, v103, v102, s61
    v_bitop3_b32 v137, v45, v46, v7 bitop3:0x56
    v_cmp_lt_u32 vcc, 15, v137
    s_cmp_lg_u64 vcc, 0
    s_cselect_b32 s54, 512, 0
    s_or_b32 s35, s35, s54
    v_perm_b32 v45, v105, v104, s60
    v_perm_b32 v46, v107, v106, s61
    v_bitop3_b32 v138, v45, v46, v7 bitop3:0x56
    v_cmp_lt_u32 vcc, 15, v138
    s_cmp_lg_u64 vcc, 0
    s_cselect_b32 s54, 1024, 0
    s_or_b32 s35, s35, s54
    v_perm_b32 v45, v109, v108, s60
    v_perm_b32 v46, v111, v110, s61
    v_bitop3_b32 v139, v45, v46, v7 bitop3:0x56
    v_cmp_lt_u32 vcc, 15, v139
    s_cmp_lg_u64 vcc, 0
    s_cselect_b32 s54, 2048, 0
    s_or_b32 s35, s35, s54
    v_perm_b32 v45, v113, v112, s60
    v_perm_b32 v46, v115, v114, s61
    v_bitop3_b32 v140, v45, v46, v7 bitop3:0x56
    v_cmp_lt_u32 vcc, 15, v140
    s_cmp_lg_u64 vcc, 0
    s_cselect_b32 s54, 4096, 0
    s_or_b32 s35, s35, s54
    v_perm_b32 v45, v117, v116, s60
    v_perm_b32 v46, v119, v118, s61
    v_bitop3_b32 v141, v45, v46, v7 bitop3:0x56
    v_cmp_lt_u32 vcc, 15, v141
    s_cmp_lg_u64 vcc, 0
    s_cselect_b32 s54, 8192, 0
    s_or_b32 s35, s35, s54
    v_perm_b32 v45, v121, v120, s60
    v_perm_b32 v46, v123, v122, s61
    v_bitop3_b32 v142, v45, v46, v7 bitop3:0x56
    v_cmp_lt_u32 vcc, 15, v142
    s_cmp_lg_u64 vcc, 0
    s_cselect_b32 s54, 16384, 0
    s_or_b32 s35, s35, s54
    v_perm_b32 v45, v125, v124, s60
    v_perm_b32 v46, v127, v126, s61
    v_bitop3_b32 v143, v45, v46, v7 bitop3:0x56
    v_cmp_lt_u32 vcc, 15, v143
    s_cmp_lg_u64 vcc, 0
    s_cselect_b32 s54, 32768, 0
    s_or_b32 s35, s35, s54
    s_cbranch_scc0 L_h0_done
    s_sub_u32 s62, s62, 1
    s_cbranch_scc1 L_h0_done
    s_cmp_lg_u32 s62, 99988
    s_cbranch_scc1 L_h0_nopub
    buffer_store_dwordx4 v[32:35], v6, s[36:39], s50 offen sc1
L_h0_nopub:
    s_sleep 1
    s_branch L_h0
L_h0_done:
    v_add_f32 v64, v64, v68
    v_add_f32 v72, v72, v76
    v_add_f32 v65, v65, v69
    v_add_f32 v73, v73, v77
    v_add_f32 v66, v66, v70
    v_add_f32 v74, v74, v78
    v_add_f32 v67, v67, v71
    v_add_f32 v75, v75, v79
    v_add_f32 v64, v64, v72
    v_add_f32 v65, v65, v73
    v_add_f32 v66, v66, v74
    v_add_f32 v67, v67, v75
    v_cvt_pk_bf16_f32 v64, v64, v65
    v_cvt_pk_bf16_f32 v65, v66, v67
    ds_write_b64 v15, v[64:65] offset:0
    v_add_f32 v80, v80, v84
    v_add_f32 v88, v88, v92
    v_add_f32 v81, v81, v85
    v_add_f32 v89, v89, v93
    v_add_f32 v82, v82, v86
    v_add_f32 v90, v90, v94
    v_add_f32 v83, v83, v87
    v_add_f32 v91, v91, v95
    v_add_f32 v80, v80, v88
    v_add_f32 v81, v81, v89
    v_add_f32 v82, v82, v90
    v_add_f32 v83, v83, v91
    v_cvt_pk_bf16_f32 v80, v80, v81
    v_cvt_pk_bf16_f32 v81, v82, v83
    ds_write_b64 v15, v[80:81] offset:512
    v_add_f32 v96, v96, v100
    v_add_f32 v104, v104, v108
    v_add_f32 v97, v97, v101
    v_add_f32 v105, v105, v109
    v_add_f32 v98, v98, v102
    v_add_f32 v106, v106, v110
    v_add_f32 v99, v99, v103
    v_add_f32 v107, v107, v111
    v_add_f32 v96, v96, v104
    v_add_f32 v97, v97, v105
    v_add_f32 v98, v98, v106
    v_add_f32 v99, v99, v107
    v_cvt_pk_bf16_f32 v96, v96, v97
    v_cvt_pk_bf16_f32 v97, v98, v99
    ds_write_b64 v15, v[96:97] offset:1024
    v_add_f32 v112, v112, v116
    v_add_f32 v120, v120, v124
    v_add_f32 v113, v113, v117
    v_add_f32 v121, v121, v125
    v_add_f32 v114, v114, v118
    v_add_f32 v122, v122, v126
    v_add_f32 v115, v115, v119
    v_add_f32 v123, v123, v127
    v_add_f32 v112, v112, v120
    v_add_f32 v113, v113, v121
    v_add_f32 v114, v114, v122
    v_add_f32 v115, v115, v123
    v_cvt_pk_bf16_f32 v112, v112, v113
    v_cvt_pk_bf16_f32 v113, v114, v115
    ds_write_b64 v15, v[112:113] offset:1536
    v_mov_b32 v8, 0
    v_or3_b32 v128, v128, v129, v130
    v_or3_b32 v131, v131, v132, v133
    v_or3_b32 v134, v134, v135, v136
    v_or3_b32 v137, v137, v138, v139
    v_or3_b32 v140, v140, v141, v142
    v_or3_b32 v128, v128, v131, v134
    v_or3_b32 v137, v137, v140, v143
    v_or_b32 v128, v128, v137
    v_cmp_ne_u32 vcc, 0, v128
    s_cmp_lg_u64 vcc, 0
    s_cselect_b32 s63, 1, 2
    v_mov_b32 v9, s63
    s_waitcnt lgkmcnt(0)
    ds_write_b32 v8, v9 offset:18816
    s_cmp_eq_u32 s63, 2
    s_cbranch_scc1 L_h0_near
    buffer_store_dwordx4 v[32:35], v6, s[36:39], s50 offen sc1
L_h0_near:
    v_and_b32 v9, 31, v0
    s_mov_b32 exec_hi, 0
    v_lshlrev_b32 v8, 12, v9
    s_lshl_b32 s54, s31, 17
    s_lshl_b32 s98, s34, 7
    s_add_u32 s54, s54, s98
    s_add_u32 s54, s54, 0x80000
    buffer_load_dword v56, v8, s[36:39], s54 offen sc1
    s_mov_b32 exec_lo, 0x0fffffff
    v_lshlrev_b32 v57, 14, v9
    s_lshr_b32 s54, s34, 4
    s_mul_i32 s54, s54, 458752
    s_and_b32 s55, s34, 15
    s_lshl_b32 s98, s31, 4
    s_add_u32 s55, s55, s98
    s_lshl_b32 s55, s55, 7
    s_add_u32 s54, s54, s55
    s_add_u32 s54, s54, 0x200000
    buffer_load_dword v57, v57, s[36:39], s54 offen sc1
    s_mov_b64 exec, -1
    s_waitcnt vmcnt(0)
    s_endpgm
L_end:
    s_endpgm
.section .rodata,"a"
.p2align 6
.amdhsa_kernel concat_heads__gqa_block_cached__sliding_block_cached__decode_kernel
  .amdhsa_next_free_vgpr 256
  .amdhsa_next_free_sgpr 102
  .amdhsa_accum_offset 256
  .amdhsa_group_segment_fixed_size 0
  .amdhsa_kernarg_size 104
  .amdhsa_user_sgpr_count 2
  .amdhsa_user_sgpr_kernarg_segment_ptr 1
  .amdhsa_system_sgpr_workgroup_id_x 1
.end_amdhsa_kernel
```
